```python
import torch

def _softmax(x, axis=-1):
    return torch.softmax(x, dim=axis)
def _gelu(x):
    return torch.nn.functional.gelu(x, approximate="tanh")
def _silu(x):
    return torch.nn.functional.silu(x)
def _sigmoid(x):
    return torch.sigmoid(x)
def _layernorm(x, axis=-1, eps=1e-5):
    m = x.mean(dim=axis, keepdim=True)
    v = x.var(dim=axis, keepdim=True, unbiased=False)
    return (x - m) / torch.sqrt(v + eps)
def _scatter_add(tgt, idx, src, axis=0):
    return tgt.clone().index_add_(axis, idx, src)
def _segment_sum(src, seg, n):
    out = torch.zeros((n,) + src.shape[1:], dtype=src.dtype)
    return out.index_add_(0, seg, src)
def _pad(x, pw):
    flat = tuple(v for pair in reversed(pw) for v in pair)
    return torch.nn.functional.pad(x, flat)

kernel_name = 'recurrent_scan__ssm_conv_s4d__dense_activation_mish__prompt'

def setup_inputs():

    _w = (lambda a: (lambda t: t.to(torch.bfloat16) if t.is_floating_point() else t)(torch.as_tensor(a)))
    def _A_setup():
        Bsz, L, D, N = 1, 2048, 512, 128
        return {
            "u": _w((lambda *s: torch.randn(*s, dtype=torch.bfloat16) * 0.05)(Bsz, L, D)),
            "log_A_real": _w((lambda *s: torch.randn(*s, dtype=torch.bfloat16) * 3.2)(D, N) * 0.5),
            "A_imag": _w((lambda *s: torch.randn(*s, dtype=torch.bfloat16) * 0.2)(D, N) * 3.14),
            "C_real": _w((lambda *s: torch.randn(*s, dtype=torch.bfloat16) * 0.8)(D, N) / N ** 0.5),
            "C_imag": _w((lambda *s: torch.randn(*s, dtype=torch.bfloat16) * 0.8)(D, N) / N ** 0.5),
            "log_dt": _w((lambda *s: torch.randn(*s, dtype=torch.bfloat16) * 0.2)(D) * 0.5 - 4.0),
            "D_skip": _w((lambda *s: torch.randn(*s, dtype=torch.bfloat16) * 0.2)(D)),
        }
    _A_in = _A_setup()

    def _B_setup():
        B, S, D, F = 1, 2048, 512, 1792
        return {
            "x": _w((lambda *s: torch.randn(*s, dtype=torch.bfloat16) * 0.05)(B, S, D)),
            "w1": _w((lambda *s: torch.randn(*s, dtype=torch.bfloat16) * 0.8)(D, F) * (D ** -0.5)),
            "b1": _w((lambda *s: torch.randn(*s, dtype=torch.bfloat16) * 0.4)(F)),
            "w2": _w((lambda *s: torch.randn(*s, dtype=torch.bfloat16) * 0.1)(F, D) * (F ** -0.5)),
        }
    _B_in = _B_setup()

    return {
        "A_u": _A_in["u"],
        "A_log_A_real": _A_in["log_A_real"],
        "A_A_imag": _A_in["A_imag"],
        "A_C_real": _A_in["C_real"],
        "A_C_imag": _A_in["C_imag"],
        "A_log_dt": _A_in["log_dt"],
        "A_D_skip": _A_in["D_skip"],
        "B_x": _B_in["x"],
        "B_w1": _B_in["w1"],
        "B_b1": _B_in["b1"],
        "B_w2": _B_in["w2"],
    }

def reference(A_u, A_log_A_real, A_A_imag, A_C_real, A_C_imag, A_log_dt, A_D_skip, B_x, B_w1, B_b1, B_w2):
    def _A_ref(u, log_A_real, A_imag, C_real, C_imag, log_dt, D_skip):
        L = u.shape[1]
        dt = torch.exp(log_dt)
        A = -torch.exp(log_A_real) + 1j * A_imag
        C = (C_real + 1j * C_imag) * dt[:, None]
        pos = (lambda x, dt: x.to(dt))(torch.arange(L), log_dt.dtype)
        P = torch.exp((A * dt[:, None])[:, :, None] * pos[None, None, :])
        K = 2.0 * torch.einsum("dn,dnl->dl", C, P).real
        L2 = 2 * L
        u_t = (lambda x, *d: x.permute(*d))(u, 0, 2, 1)
        Kf = (lambda x, *a, **k: torch.fft.rfft(x.float(), *a, **k))(K, L2)
        Uf = (lambda x, *a, **k: torch.fft.rfft(x.float(), *a, **k))(u_t, L2)
        y = (lambda x, *a, **k: torch.fft.irfft(x, *a, **k).to(torch.bfloat16))(Uf * Kf[None, :, :], L2)[:, :, :L]
        y = (lambda x, *d: x.permute(*d))(y, 0, 2, 1)
        return y + u * D_skip[None, None, :]

    def _B_ref(x, w1, b1, w2):
        h = torch.einsum("bsd,df->bsf", x, w1) + b1
        sp = torch.log1p(torch.exp(-torch.abs(h))) + torch.where(h > 0, h, torch.zeros_like(h))
        act = h * torch.tanh(sp)
        return torch.einsum("bsf,fd->bsd", act, w2)

    x = A_u
    xn = _layernorm(x, axis=-1)
    s = _A_ref(xn, A_log_A_real, A_A_imag, A_C_real, A_C_imag, A_log_dt, A_D_skip)
    g = _silu(_B_ref(xn, B_w1, B_b1, B_w2))
    return x + s * g
```

```asm
; @launch grid=(256,1,1) block=(512,1,1) lds=163840
.amdgcn_target "amdgcn-amd-amdhsa--gfx950"
.text
.globl recurrent_scan__ssm_conv_s4d__dense_activation_mish__prompt_kernel
.p2align 8
.type recurrent_scan__ssm_conv_s4d__dense_activation_mish__prompt_kernel,@function
recurrent_scan__ssm_conv_s4d__dense_activation_mish__prompt_kernel:
    s_load_dwordx16 s[4:19], s[0:1], 0
    s_load_dwordx8 s[20:27], s[0:1], 64
    s_load_dwordx4 s[28:31], s[0:1], 96
    s_cmp_ge_u32 s2, 256
    s_cbranch_scc1 Lend
    s_getpc_b64 s[34:35]
Lpc:
    s_bfe_u32 s70, s2, 0x30003
    s_lshl_b32 s70, s70, 7
    v_lshl_add_u32 v12, v0, 10, s70
    v_cmp_gt_u32 vcc, Ltabend-Lpc-4, v12
    s_nop 3
    s_and_saveexec_b64 s[72:73], vcc
    s_cbranch_execz Lnopf
    global_load_dword v13, v12, s[34:35]
Lnopf:
    s_mov_b64 exec, s[72:73]
    v_lshrrev_b32 v4, 6, v0
    s_and_b32 s60, s2, 7
    v_readfirstlane_b32 s67, v4
    s_lshr_b32 s61, s2, 3
    s_lshl_b32 s62, s60, 5
    s_add_u32 s62, s62, s61
    v_mov_b32 v9, 0
    v_mov_b32 v11, 163072
    v_lshl_add_u32 v8, v4, 2, v11
    ds_write_b32 v8, v9
    ds_write_b32 v11, v9 offset:64
    v_and_b32 v1, 63, v0
    s_cmp_ge_u32 s67, 4
    s_cbranch_scc1 LY
    s_lshl_b32 s72, s62, 9
    v_lshl_add_u32 v17, v0, 1, s72
    s_lshl_b32 s70, s62, 13
    v_lshl_add_u32 v16, v0, 4, s70
    v_lshl_add_u32 v16, v4, 10, v16
    s_waitcnt lgkmcnt(0)
    global_load_dwordx4 v[24:27], v16, s[4:5]
    global_load_dwordx4 v[28:31], v16, s[4:5] offset:1024
    global_load_ushort v208, v17, s[6:7]
    global_load_ushort v209, v17, s[8:9]
    global_load_ushort v210, v17, s[10:11]
    global_load_ushort v211, v17, s[12:13]
    s_barrier
    s_lshl_b32 s72, s62, 2
    s_load_dword s3, s[30:31], 0
    s_load_dword s92, s[14:15], s72
    s_load_dword s93, s[16:17], s72
    s_branch LX
LY:
    s_and_b32 s94, s67, 3
    s_and_b32 s70, s61, 3
    s_lshr_b32 s71, s60, 1
    s_lshl_b32 s63, s71, 2
    s_add_u32 s63, s63, s70
    s_lshr_b32 s66, s61, 2
    s_and_b32 s72, s60, 1
    s_mul_i32 s72, s72, 7
    s_add_u32 s64, s72, s66
    s_mov_b32 s43, 0x20000
    s_cmp_ge_u32 s61, 28
    s_cbranch_scc1 LYs
    s_lshl_b32 s68, s70, 1
    s_add_u32 s68, s68, s66
    v_lshrrev_b32 v18, 3, v1
    v_lshrrev_b32 v19, 4, v1
    v_and_b32 v20, 7, v1
    v_lshlrev_b32 v18, 10, v18
    v_lshl_add_u32 v22, v20, 4, v18
    v_xor_b32 v20, v20, v19
    s_lshl_b32 s70, s94, 15
    v_lshl_add_u32 v248, v20, 4, v18
    v_add_u32 v248, s70, v248
    v_xor_b32 v249, 64, v248
    v_add_u32 v249, 7168, v249
    s_lshl_b32 s70, s94, 4
    v_add_u32 v250, s70, v19
    v_mul_u32_u24 v250, 3584, v250
    v_and_b32 v20, 15, v1
    v_lshlrev_b32 v21, 2, v19
    v_xor_b32 v20, v20, v21
    v_lshl_add_u32 v250, v20, 4, v250
    v_add_u32 v251, 13312, v250
    v_xor_b32 v252, 16, v250
    v_xor_b32 v253, 16, v251
    s_lshl_b32 s69, s94, 13
    s_mov_b32 s39, 0x20000
    s_mov_b32 s38, s39
    s_lshl_b32 s97, s64, 8
    s_sub_u32 s42, 1837056, s97
    s_lshl_b32 s96, s63, 17
    s_waitcnt lgkmcnt(0)
    s_add_u32 s36, s4, s96
    s_addc_u32 s37, s5, 0
    s_add_u32 s40, s20, s97
    s_addc_u32 s41, s21, 0
    s_sub_u32 s40, s40, 2048
    s_subb_u32 s41, s41, 0
    s_barrier
    s_add_u32 s96, s68, 0
    s_and_b32 s96, s96, 7
    s_add_u32 m0, s69, 98304
    s_mul_i32 s97, s96, 229376
    s_lshl_b32 s96, s96, 7
    buffer_load_dwordx4 v248, s[36:39], s96 offen lds
    buffer_load_dwordx4 v250, s[40:43], s97 offen offset:2048 lds
    buffer_load_dwordx4 v249, s[36:39], s96 offen offset:1024 lds
    buffer_load_dwordx4 v251, s[40:43], s97 offen offset:3072 lds
    s_lshl_b32 s72, s62, 2
    s_load_dword s3, s[30:31], 0
    s_load_dword s92, s[14:15], s72
    s_load_dword s93, s[16:17], s72
    s_cmp_lg_u32 s94, 0
    s_cbranch_scc1 Lnoinit15
    s_lshl_b32 s72, s62, 7
    s_add_u32 s72, s72, 786432
    s_mov_b32 s51, 0
    s_atomic_swap s51, s[30:31], s72
Lnoinit15:
    s_add_u32 s95, s69, 65536
    s_mov_b32 m0, s95
    s_mul_i32 s70, s60, 28
    s_add_u32 s70, s70, s61
    s_lshr_b32 s71, s70, 1
    s_and_b32 s70, s70, 1
    s_lshl_b32 s70, s70, 2
    s_add_u32 s70, s70, s94
    s_lshl_b32 s32, s71, 14
    s_lshl_b32 s73, s70, 7
    s_add_u32 s32, s32, s73
    s_add_u32 s33, s32, 7168
    s_mov_b32 s52, s24
    s_mov_b32 s53, s25
    s_mov_b32 s54, 1835008
    s_mov_b32 s55, 0x20000
    buffer_load_dwordx4 v22, s[52:55], s32 offen lds
    buffer_load_dwordx4 v22, s[52:55], s33 offen offset:1024 lds
    s_add_u32 m0, s69, 102400
    s_add_u32 s96, s96, 16384
    s_add_u32 s97, s97, 28672
    buffer_load_dwordx4 v248, s[36:39], s96 offen lds
    buffer_load_dwordx4 v252, s[40:43], s97 offen offset:2048 lds
    buffer_load_dwordx4 v249, s[36:39], s96 offen offset:1024 lds
    buffer_load_dwordx4 v253, s[40:43], s97 offen offset:3072 lds
    s_mul_i32 s32, s70, 56
    s_lshr_b32 s73, s71, 1
    s_add_u32 s32, s32, s73
    s_lshl_b32 s32, s32, 12
    s_and_b32 s73, s71, 1
    s_lshl_b32 s73, s73, 9
    s_add_u32 s32, s32, s73
    s_add_u32 s32, s32, 3407872
    s_mov_b32 s44, s30
    s_mov_b32 s45, s31
    s_mov_b32 s46, 16777216
    s_mov_b32 s47, 0x20000
    v_lshlrev_b32 v3, 4, v1
    v_and_b32 v12, 255, v0
    s_and_b32 s73, s61, 3
    s_lshl_b32 s65, s60, 2
    s_add_u32 s65, s65, s73
    s_lshr_b32 s19, s94, 1
    v_bfe_u32 v18, v1, 2, 2
    v_and_b32 v19, 3, v1
    v_lshlrev_b32 v76, 10, v18
    v_lshl_add_u32 v76, v19, 3, v76
    v_lshrrev_b32 v77, 4, v12
    v_lshl_add_u32 v76, v77, 5, v76
    v_add_u32 v76, 147968, v76
    v_lshrrev_b32 v79, 5, v1
    v_bfe_u32 v78, v1, 4, 1
    v_lshl_add_u32 v77, v79, 2, v18
    v_lshlrev_b32 v77, 7, v77
    v_lshl_add_u32 v77, v19, 3, v77
    v_lshl_add_u32 v77, v78, 5, v77
    v_add_u32 v77, s95, v77
    v_and_b32 v72, 15, v1
    v_lshlrev_b32 v72, 4, v72
    v_lshl_add_u32 v72, v79, 8, v72
    v_lshl_add_u32 v72, v78, 10, v72
    v_lshlrev_b32 v78, 4, v12
    v_and_b32 v79, 7, v1
    v_lshl_add_u32 v75, v79, 2, v11
    v_lshlrev_b32 v79, 3, v79
    s_lshl_b32 s70, s62, 6
    s_add_u32 s70, s70, 16384
    s_cmp_lg_u32 s94, 0
    s_cselect_b32 s24, 16777216, s70
    s_mul_i32 s71, s62, 8448
    s_add_u32 s22, s71, 1048576
    s_add_u32 s23, s22, 4096
    s_waitcnt lgkmcnt(0)
    v_cmp_gt_u32 s[14:15], 32, v1
    s_mul_i32 s3, s3, 0x9E3779B1
    s_add_u32 s3, s3, 0x3C6EF35F
    v_mov_b32 v2, s3
    s_lshl_b32 s73, s19, 4
    s_lshr_b32 s93, s93, s73
    s_lshl_b32 s93, s93, 16
    s_lshr_b32 s92, s92, s73
    s_lshl_b32 s92, s92, 16
    v_mov_b32 v71, v2
    ds_read_b128 v[48:51], v11 offset:0
    s_waitcnt lgkmcnt(0)
    v_min_u32 v48, v48, v49
    v_min3_u32 v48, v48, v50, v51
    v_cmp_gt_u32 vcc, 1, v48
    s_nop 4
    s_cbranch_vccnz Lretry16
Ldone16:
    ds_read_b64_tr_b16 v[32:33], v76 offset:0
    ds_read_b64_tr_b16 v[34:35], v76 offset:4096
    ds_read_b64_tr_b16 v[36:37], v76 offset:512
    ds_read_b64_tr_b16 v[38:39], v76 offset:4608
    ds_read_b32 v70, v75 offset:32
    v_mov_b32 v10, 1
    ds_write_b32 v8, v10
    s_waitcnt lgkmcnt(4)
    buffer_store_dwordx4 v[32:35], v78, s[44:47], s22 offen sc1
    s_waitcnt lgkmcnt(2)
    buffer_store_dwordx4 v[36:39], v78, s[44:47], s23 offen sc1
    s_waitcnt lgkmcnt(1)
    s_cmp_lg_u32 s94, 0
    s_cbranch_scc1 Lnst17
    buffer_store_dwordx2 v[70:71], v79, s[44:47], s24 offen sc1
Lnst17:
    s_waitcnt vmcnt(6)
    ds_read_b64_tr_b16 v[80:81], v77 offset:0
    ds_read_b64_tr_b16 v[82:83], v77 offset:1024
    ds_read_b64_tr_b16 v[84:85], v77 offset:64
    ds_read_b64_tr_b16 v[86:87], v77 offset:1088
    s_waitcnt lgkmcnt(2)
    buffer_store_dwordx4 v[80:83], v72, s[44:47], s32 offen offset:0 sc1
    s_waitcnt lgkmcnt(0)
    buffer_store_dwordx4 v[84:87], v72, s[44:47], s32 offen offset:2048 sc1
    s_add_u32 s96, s68, 1
    s_and_b32 s96, s96, 7
    s_add_u32 m0, s69, 0
    s_mul_i32 s97, s96, 229376
    s_lshl_b32 s96, s96, 7
    buffer_load_dwordx4 v248, s[36:39], s96 offen lds
    buffer_load_dwordx4 v250, s[40:43], s97 offen offset:2048 lds
    buffer_load_dwordx4 v249, s[36:39], s96 offen offset:1024 lds
    buffer_load_dwordx4 v251, s[40:43], s97 offen offset:3072 lds
    s_add_u32 m0, s69, 4096
    s_add_u32 s96, s96, 16384
    s_add_u32 s97, s97, 28672
    buffer_load_dwordx4 v248, s[36:39], s96 offen lds
    buffer_load_dwordx4 v252, s[40:43], s97 offen offset:2048 lds
    buffer_load_dwordx4 v249, s[36:39], s96 offen offset:1024 lds
    buffer_load_dwordx4 v253, s[40:43], s97 offen offset:3072 lds
    s_add_u32 s8, s34, Ltab-Lpc
    s_addc_u32 s9, s35, 0
    v_and_b32 v16, 127, v0
    v_lshlrev_b32 v16, 5, v16
    v_mov_b32 v59, v16
    s_mul_i32 s73, s19, 6656
    s_add_u32 s73, s73, 147968
    v_mov_b32 v74, s73
    s_mul_i32 s73, s19, 16640
    s_add_u32 s73, s73, 98304
    v_add_u32 v16, s73, v16
    v_lshrrev_b32 v17, 1, v12
    v_and_b32 v18, 1, v12
    v_mul_u32_u24 v30, 8448, v17
    v_lshl_add_u32 v30, v18, 4, v30
    v_mul_u32_u24 v18, 4576, v18
    v_lshl_add_u32 v18, v17, 4, v18
    v_add_u32 v31, 132064, v18
    v_lshlrev_b32 v61, 6, v12
    v_add_u32 v61, 163840, v61
    v_mov_b32 v52, 0
    v_mov_b32 v53, 0
    v_mov_b32 v54, 0
    v_mov_b32 v55, 0
    v_bfe_u32 v17, v1, 2, 3
    v_mul_u32_u24 v17, 4160, v17
    v_and_b32 v19, 3, v1
    v_lshl_add_u32 v17, v19, 4, v17
    v_add_u32 v57, 102400, v17
    v_lshrrev_b32 v17, 5, v1
    v_mul_u32_u24 v17, 4576, v17
    v_and_b32 v19, 31, v1
    v_min_u32 v19, 29, v19
    v_lshl_add_u32 v17, v19, 4, v17
    v_add_u32 v58, 131584, v17
    v_and_b32 v56, 15, v1
    v_lshrrev_b32 v17, 4, v1
    v_sub_u32 v18, 15, v56
    v_and_b32 v19, 3, v18
    v_mul_u32_u24 v19, 4160, v19
    v_lshrrev_b32 v18, 2, v18
    v_lshl_add_u32 v19, v18, 3, v19
    v_lshl_add_u32 v19, v17, 4, v19
    s_and_b32 s95, s94, 1
    s_lshl_b32 s95, s95, 8
    s_sub_u32 s73, s73, s95
    v_add_u32 v136, s73, v19
    s_mul_i32 s73, s19, 4576
    s_add_u32 s73, s73, 131840
    s_sub_u32 s73, s73, s95
    v_lshlrev_b32 v19, 5, v56
    v_lshl_add_u32 v19, v17, 4, v19
    v_add_u32 v137, s73, v19
    v_lshrrev_b32 v18, 1, v17
    v_lshlrev_b32 v138, 5, v56
    v_lshl_add_u32 v138, v18, 4, v138
    v_and_b32 v142, 1, v17
    s_lshl_b32 s73, s94, 12
    s_add_u32 s73, s73, 140736
    v_add_u32 v139, s73, v3
    s_xor_b32 s73, s94, 1
    s_lshl_b32 s73, s73, 12
    s_add_u32 s73, s73, 140736
    v_add_u32 v140, s73, v3
    s_and_b32 s71, s61, 3
    s_lshl_b32 s71, s71, 1
    s_add_u32 s70, s66, s71
    s_sub_u32 s71, s70, 7
    s_min_u32 s70, s70, s71
    s_lshl_b32 s76, s70, 12
    s_add_u32 s70, s76, 4096
    s_sub_u32 s71, s70, 28672
    s_min_u32 s77, s70, s71
    s_add_u32 s70, s76, 8192
    s_sub_u32 s71, s70, 28672
    s_min_u32 s78, s70, s71
    s_add_u32 s70, s76, 12288
    s_sub_u32 s71, s70, 28672
    s_min_u32 s79, s70, s71
    s_add_u32 s70, s76, 16384
    s_sub_u32 s71, s70, 28672
    s_min_u32 s80, s70, s71
    s_add_u32 s70, s76, 20480
    s_sub_u32 s71, s70, 28672
    s_min_u32 s81, s70, s71
    s_add_u32 s70, s76, 24576
    s_sub_u32 s71, s70, 28672
    s_min_u32 s82, s70, s71
    s_lshr_b32 s83, s76, 2
    s_lshr_b32 s84, s77, 2
    s_lshr_b32 s85, s78, 2
    s_lshr_b32 s86, s79, 2
    s_lshr_b32 s87, s80, 2
    s_lshr_b32 s88, s81, 2
    s_lshr_b32 s89, s82, 2
    s_and_b32 s96, s66, 1
    s_lshl_b32 s96, s96, 2
    s_xor_b32 s96, s96, s67
    s_mul_i32 s71, s96, 28672
    s_mul_i32 s70, s66, 229376
    s_add_u32 s70, s70, s71
    s_add_u32 s70, s70, 3407872
    v_add_u32 v4, s70, v3
    s_mul_i32 s70, s65, 229376
    s_lshr_b32 s71, s71, 2
    s_add_u32 s70, s70, s71
    s_add_u32 s70, s70, 7602176
    v_add_u32 v5, s70, v3
    s_lshr_b32 s70, s96, 2
    s_lshl_b32 s71, s65, 2
    s_add_u32 s70, s70, s71
    s_lshl_b32 s70, s70, 7
    s_add_u32 s48, s70, 786432
    s_add_u32 s49, s48, 256
    s_lshl_b32 s6, s62, 5
    s_add_u32 s6, s6, 1048576
    s_add_u32 s7, s6, 1081344
    s_lshl_b32 s28, s62, 6
    s_add_u32 s28, s28, 163840
    s_waitcnt vmcnt(8)
    v_mov_b32 v63, 1
    s_mov_b64 exec, 1
    ds_add_rtn_u32 v63, v11, v63 offset:64
    s_mov_b64 exec, -1
    s_add_u32 s96, s68, 2
    s_and_b32 s96, s96, 7
    s_add_u32 m0, s69, 32768
    s_mul_i32 s97, s96, 229376
    s_lshl_b32 s96, s96, 7
    buffer_load_dwordx4 v248, s[36:39], s96 offen lds
    buffer_load_dwordx4 v250, s[40:43], s97 offen offset:2048 lds
    buffer_load_dwordx4 v249, s[36:39], s96 offen offset:1024 lds
    buffer_load_dwordx4 v251, s[40:43], s97 offen offset:3072 lds
    s_waitcnt lgkmcnt(0)
    v_readfirstlane_b32 s70, v63
    s_mov_b32 s51, s3
    s_nop 2
    s_cmp_lg_u32 s70, 3
    s_cbranch_scc1 Lnof18
    s_atomic_swap s51, s[30:31], s28
Lnof18:
    s_add_u32 m0, s69, 36864
    s_add_u32 s96, s96, 16384
    s_add_u32 s97, s97, 28672
    buffer_load_dwordx4 v248, s[36:39], s96 offen lds
    buffer_load_dwordx4 v252, s[40:43], s97 offen offset:2048 lds
    buffer_load_dwordx4 v249, s[36:39], s96 offen offset:1024 lds
    buffer_load_dwordx4 v253, s[40:43], s97 offen offset:3072 lds
    s_barrier
    s_add_u32 s96, s68, 3
    s_and_b32 s96, s96, 7
    s_add_u32 m0, s69, 65536
    s_mul_i32 s97, s96, 229376
    s_lshl_b32 s96, s96, 7
    buffer_load_dwordx4 v248, s[36:39], s96 offen lds
    buffer_load_dwordx4 v250, s[40:43], s97 offen offset:2048 lds
    buffer_load_dwordx4 v249, s[36:39], s96 offen offset:1024 lds
    buffer_load_dwordx4 v251, s[40:43], s97 offen offset:3072 lds
    s_add_u32 m0, s69, 69632
    s_add_u32 s96, s96, 16384
    s_add_u32 s97, s97, 28672
    buffer_load_dwordx4 v248, s[36:39], s96 offen lds
    buffer_load_dwordx4 v252, s[40:43], s97 offen offset:2048 lds
    buffer_load_dwordx4 v249, s[36:39], s96 offen offset:1024 lds
    buffer_load_dwordx4 v253, s[40:43], s97 offen offset:3072 lds
    s_waitcnt vmcnt(16)
    s_barrier
    s_add_u32 s96, s68, 4
    s_and_b32 s96, s96, 7
    s_add_u32 m0, s69, 98304
    s_mul_i32 s97, s96, 229376
    s_lshl_b32 s96, s96, 7
    buffer_load_dwordx4 v248, s[36:39], s96 offen lds
    buffer_load_dwordx4 v250, s[40:43], s97 offen offset:2048 lds
    buffer_load_dwordx4 v249, s[36:39], s96 offen offset:1024 lds
    buffer_load_dwordx4 v251, s[40:43], s97 offen offset:3072 lds
    s_add_u32 m0, s69, 102400
    s_add_u32 s96, s96, 16384
    s_add_u32 s97, s97, 28672
    buffer_load_dwordx4 v248, s[36:39], s96 offen lds
    buffer_load_dwordx4 v252, s[40:43], s97 offen offset:2048 lds
    buffer_load_dwordx4 v249, s[36:39], s96 offen offset:1024 lds
    buffer_load_dwordx4 v253, s[40:43], s97 offen offset:3072 lds
    global_load_dwordx4 v[20:23], v59, s[8:9]
    global_load_dwordx4 v[24:27], v59, s[8:9] offset:16
    global_load_dwordx2 v[28:29], v59, s[8:9] offset:32
    s_waitcnt vmcnt(19)
    s_barrier
    s_add_u32 s96, s68, 5
    s_and_b32 s96, s96, 7
    s_add_u32 m0, s69, 0
    s_mul_i32 s97, s96, 229376
    s_lshl_b32 s96, s96, 7
    buffer_load_dwordx4 v248, s[36:39], s96 offen lds
    buffer_load_dwordx4 v250, s[40:43], s97 offen offset:2048 lds
    buffer_load_dwordx4 v249, s[36:39], s96 offen offset:1024 lds
    buffer_load_dwordx4 v251, s[40:43], s97 offen offset:3072 lds
    s_add_u32 m0, s69, 4096
    s_add_u32 s96, s96, 16384
    s_add_u32 s97, s97, 28672
    buffer_load_dwordx4 v248, s[36:39], s96 offen lds
    buffer_load_dwordx4 v252, s[40:43], s97 offen offset:2048 lds
    buffer_load_dwordx4 v249, s[36:39], s96 offen offset:1024 lds
    buffer_load_dwordx4 v253, s[40:43], s97 offen offset:3072 lds
    s_waitcnt vmcnt(19)
    s_barrier
    s_add_u32 s96, s68, 6
    s_and_b32 s96, s96, 7
    s_add_u32 m0, s69, 32768
    s_mul_i32 s97, s96, 229376
    s_lshl_b32 s96, s96, 7
    buffer_load_dwordx4 v248, s[36:39], s96 offen lds
    buffer_load_dwordx4 v250, s[40:43], s97 offen offset:2048 lds
    buffer_load_dwordx4 v249, s[36:39], s96 offen offset:1024 lds
    buffer_load_dwordx4 v251, s[40:43], s97 offen offset:3072 lds
    s_add_u32 m0, s69, 36864
    s_add_u32 s96, s96, 16384
    s_add_u32 s97, s97, 28672
    buffer_load_dwordx4 v248, s[36:39], s96 offen lds
    buffer_load_dwordx4 v252, s[40:43], s97 offen offset:2048 lds
    buffer_load_dwordx4 v249, s[36:39], s96 offen offset:1024 lds
    buffer_load_dwordx4 v253, s[40:43], s97 offen offset:3072 lds
    global_load_dword v60, v61, s[30:31] sc1
    s_waitcnt vmcnt(0)
    v_cmp_ne_u32 vcc, s3, v60
    s_nop 4
    s_cbranch_vccnz Lretry19
Ldone19:
    s_barrier
    v_mov_b32 v10, 6
    ds_write_b32 v8, v10
    s_add_u32 s96, s68, 7
    s_and_b32 s96, s96, 7
    s_add_u32 m0, s69, 65536
    s_mul_i32 s97, s96, 229376
    s_lshl_b32 s96, s96, 7
    buffer_load_dwordx4 v248, s[36:39], s96 offen lds
    buffer_load_dwordx4 v250, s[40:43], s97 offen offset:2048 lds
    buffer_load_dwordx4 v249, s[36:39], s96 offen offset:1024 lds
    buffer_load_dwordx4 v251, s[40:43], s97 offen offset:3072 lds
    s_add_u32 m0, s69, 69632
    s_add_u32 s96, s96, 16384
    s_add_u32 s97, s97, 28672
    buffer_load_dwordx4 v248, s[36:39], s96 offen lds
    buffer_load_dwordx4 v252, s[40:43], s97 offen offset:2048 lds
    buffer_load_dwordx4 v249, s[36:39], s96 offen offset:1024 lds
    buffer_load_dwordx4 v253, s[40:43], s97 offen offset:3072 lds
    v_mov_b32 v10, 7
    ds_write_b32 v8, v10
    s_branch LYjoin
LX:
    s_and_b32 s94, s67, 3
    s_and_b32 s70, s61, 3
    s_lshr_b32 s71, s60, 1
    s_lshl_b32 s63, s71, 2
    s_add_u32 s63, s63, s70
    s_lshr_b32 s66, s61, 2
    s_and_b32 s72, s60, 1
    s_mul_i32 s72, s72, 7
    s_add_u32 s64, s72, s66
    s_mov_b32 s44, s30
    s_mov_b32 s45, s31
    s_mov_b32 s46, 16777216
    s_mov_b32 s47, 0x20000
    v_lshlrev_b32 v3, 4, v1
    v_and_b32 v12, 255, v0
    s_and_b32 s73, s61, 3
    s_lshl_b32 s65, s60, 2
    s_add_u32 s65, s65, s73
    s_lshr_b32 s19, s94, 1
    s_lshl_b32 s71, s94, 11
    s_add_u32 s71, s71, 147968
    v_add_u32 v17, s71, v3
    v_lshrrev_b32 v79, 5, v0
    v_lshlrev_b32 v79, 2, v79
    v_add_u32 v79, 163104, v79
    s_mov_b32 s56, s22
    s_mov_b32 s57, s23
    s_mov_b32 s58, 3584
    s_mov_b32 s59, 0x20000
    v_cmp_gt_u32 s[20:21], 32, v1
    s_waitcnt vmcnt(4)
    v_lshlrev_b32 v32, 16, v24
    v_and_b32 v33, 0xffff0000, v24
    v_lshlrev_b32 v34, 16, v25
    v_and_b32 v35, 0xffff0000, v25
    v_lshlrev_b32 v36, 16, v26
    v_and_b32 v37, 0xffff0000, v26
    v_lshlrev_b32 v38, 16, v27
    v_and_b32 v39, 0xffff0000, v27
    v_readfirstlane_b32 s22, v32
    v_lshlrev_b32 v40, 16, v28
    v_and_b32 v41, 0xffff0000, v28
    v_lshlrev_b32 v42, 16, v29
    v_and_b32 v43, 0xffff0000, v29
    v_lshlrev_b32 v44, 16, v30
    v_and_b32 v45, 0xffff0000, v30
    v_lshlrev_b32 v46, 16, v31
    v_and_b32 v47, 0xffff0000, v31
    v_readfirstlane_b32 s24, v40
    v_pk_add_f32 v[48:49], v[32:33], s[22:23] op_sel_hi:[1,0] neg_lo:[0,1] neg_hi:[0,1]
    v_pk_add_f32 v[50:51], v[34:35], s[22:23] op_sel_hi:[1,0] neg_lo:[0,1] neg_hi:[0,1]
    v_pk_add_f32 v[52:53], v[36:37], s[22:23] op_sel_hi:[1,0] neg_lo:[0,1] neg_hi:[0,1]
    v_pk_add_f32 v[54:55], v[38:39], s[22:23] op_sel_hi:[1,0] neg_lo:[0,1] neg_hi:[0,1]
    v_pk_add_f32 v[56:57], v[40:41], s[24:25] op_sel_hi:[1,0] neg_lo:[0,1] neg_hi:[0,1]
    v_pk_add_f32 v[58:59], v[42:43], s[24:25] op_sel_hi:[1,0] neg_lo:[0,1] neg_hi:[0,1]
    v_pk_add_f32 v[60:61], v[44:45], s[24:25] op_sel_hi:[1,0] neg_lo:[0,1] neg_hi:[0,1]
    v_pk_add_f32 v[62:63], v[46:47], s[24:25] op_sel_hi:[1,0] neg_lo:[0,1] neg_hi:[0,1]
    v_pk_add_f32 v[64:65], v[48:49], v[50:51]
    v_pk_mul_f32 v[88:89], v[48:49], v[48:49]
    v_pk_add_f32 v[66:67], v[56:57], v[58:59]
    v_pk_mul_f32 v[90:91], v[56:57], v[56:57]
    v_pk_fma_f32 v[88:89], v[50:51], v[50:51], v[88:89]
    v_pk_fma_f32 v[90:91], v[58:59], v[58:59], v[90:91]
    v_pk_add_f32 v[64:65], v[64:65], v[52:53]
    v_pk_fma_f32 v[88:89], v[52:53], v[52:53], v[88:89]
    v_pk_add_f32 v[66:67], v[66:67], v[60:61]
    v_pk_fma_f32 v[90:91], v[60:61], v[60:61], v[90:91]
    v_pk_add_f32 v[64:65], v[64:65], v[54:55]
    v_pk_fma_f32 v[88:89], v[54:55], v[54:55], v[88:89]
    v_pk_add_f32 v[66:67], v[66:67], v[62:63]
    v_pk_fma_f32 v[90:91], v[62:63], v[62:63], v[90:91]
    v_add_f32 v64, v64, v65
    v_add_f32 v66, v66, v67
    v_add_f32 v88, v88, v89
    v_add_f32 v90, v90, v91
    v_mov_b32 v72, s24
    v_permlane32_swap_b32 v64, v66
    v_permlane32_swap_b32 v88, v90
    v_add_f32 v64, v64, v66
    v_add_f32 v88, v88, v90
    v_mov_b32 v73, s22
    v_add_f32_dpp v64, v64, v64 quad_perm:[1,0,3,2] row_mask:0xf bank_mask:0xf
    v_add_f32_dpp v88, v88, v88 quad_perm:[1,0,3,2] row_mask:0xf bank_mask:0xf
    s_nop 0
    v_add_f32_dpp v64, v64, v64 quad_perm:[2,3,0,1] row_mask:0xf bank_mask:0xf
    v_add_f32_dpp v88, v88, v88 quad_perm:[2,3,0,1] row_mask:0xf bank_mask:0xf
    s_nop 0
    v_add_f32_dpp v64, v64, v64 row_half_mirror row_mask:0xf bank_mask:0xf
    v_add_f32_dpp v88, v88, v88 row_half_mirror row_mask:0xf bank_mask:0xf
    s_nop 0
    v_add_f32_dpp v64, v64, v64 row_mirror row_mask:0xf bank_mask:0xf
    v_add_f32_dpp v88, v88, v88 row_mirror row_mask:0xf bank_mask:0xf
    v_mov_b32 v65, v64
    v_mov_b32 v89, v88
    v_cndmask_b32 v72, v72, v73, s[20:21]
    v_permlane16_swap_b32 v64, v65
    v_permlane16_swap_b32 v88, v89
    v_add_f32 v64, v64, v65
    v_add_f32 v88, v88, v89
    v_mul_f32 v64, 0x3b000000, v64
    v_mul_f32 v88, 0x3b000000, v88
    v_add_f32 v72, v72, v64
    v_fma_f32 v88, -v64, v64, v88
    v_max_f32 v88, 0, v88
    v_cvt_pk_bf16_f32 v88, v88, v88
    v_cvt_pk_bf16_f32 v72, v72, v72
    v_lshlrev_b32 v88, 16, v88
    v_lshlrev_b32 v72, 16, v72
    v_add_f32 v88, 0x3727c5ac, v88
    v_cvt_pk_bf16_f32 v88, v88, v88
    v_lshlrev_b32 v88, 16, v88
    v_sqrt_f32 v88, v88
    s_nop 0
    v_cvt_pk_bf16_f32 v88, v88, v88
    v_lshlrev_b32 v88, 16, v88
    v_rcp_f32 v69, v88
    v_cvt_pk_bf16_f32 v70, v72, v88
    v_mul_f32 v72, v72, v69
    ds_write_b32 v79, v70
    v_readlane_b32 s22, v69, 0
    v_readlane_b32 s24, v69, 32
    v_readlane_b32 s6, v72, 0
    v_readlane_b32 s7, v72, 32
    s_nop 0
    v_mov_b32 v74, s6
    v_pk_fma_f32 v[32:33], v[32:33], s[22:23], v[74:75] op_sel_hi:[1,0,0] neg_lo:[0,0,1] neg_hi:[0,0,1]
    v_pk_fma_f32 v[34:35], v[34:35], s[22:23], v[74:75] op_sel_hi:[1,0,0] neg_lo:[0,0,1] neg_hi:[0,0,1]
    v_pk_fma_f32 v[36:37], v[36:37], s[22:23], v[74:75] op_sel_hi:[1,0,0] neg_lo:[0,0,1] neg_hi:[0,0,1]
    v_pk_fma_f32 v[38:39], v[38:39], s[22:23], v[74:75] op_sel_hi:[1,0,0] neg_lo:[0,0,1] neg_hi:[0,0,1]
    v_cvt_pk_bf16_f32 v24, v32, v33
    v_cvt_pk_bf16_f32 v25, v34, v35
    v_cvt_pk_bf16_f32 v26, v36, v37
    v_cvt_pk_bf16_f32 v27, v38, v39
    ds_write_b128 v17, v[24:27] offset:0
    v_mov_b32 v74, s7
    v_pk_fma_f32 v[40:41], v[40:41], s[24:25], v[74:75] op_sel_hi:[1,0,0] neg_lo:[0,0,1] neg_hi:[0,0,1]
    v_pk_fma_f32 v[42:43], v[42:43], s[24:25], v[74:75] op_sel_hi:[1,0,0] neg_lo:[0,0,1] neg_hi:[0,0,1]
    v_pk_fma_f32 v[44:45], v[44:45], s[24:25], v[74:75] op_sel_hi:[1,0,0] neg_lo:[0,0,1] neg_hi:[0,0,1]
    v_pk_fma_f32 v[46:47], v[46:47], s[24:25], v[74:75] op_sel_hi:[1,0,0] neg_lo:[0,0,1] neg_hi:[0,0,1]
    v_cvt_pk_bf16_f32 v28, v40, v41
    v_cvt_pk_bf16_f32 v29, v42, v43
    v_cvt_pk_bf16_f32 v30, v44, v45
    v_cvt_pk_bf16_f32 v31, v46, v47
    ds_write_b128 v17, v[28:31] offset:1024
    v_mov_b32 v10, 1
    ds_write_b32 v8, v10
    s_mul_i32 s73, s94, 4224
    s_add_u32 s73, s73, 131072
    v_add_u32 v200, s73, v3
    v_bfe_u32 v201, v1, 2, 2
    v_lshrrev_b32 v204, 4, v1
    v_lshl_add_u32 v201, v204, 3, v201
    v_lshlrev_b32 v201, 4, v201
    v_and_b32 v202, 1, v1
    v_lshl_add_u32 v201, v202, 3, v201
    v_bfe_u32 v202, v1, 1, 1
    v_mul_u32_u24 v202, 2112, v202
    v_add3_u32 v201, v201, v202, s73
    s_mul_i32 s71, s94, 3328
    s_add_u32 s71, s71, 147968
    v_mov_b32 v203, s71
    v_and_b32 v202, 15, v1
    v_min_u32 v206, 5, v202
    v_mul_u32_u24 v202, 144, v202
    v_mul_u32_u24 v206, 144, v206
    v_lshl_add_u32 v204, v204, 4, v203
    v_add_u32 v202, v204, v202
    v_add_u32 v206, v204, v206
    s_waitcnt lgkmcnt(0)
    v_cmp_gt_u32 s[14:15], 32, v1
    s_mul_i32 s3, s3, 0x9E3779B1
    s_add_u32 s3, s3, 0x3C6EF35F
    v_mov_b32 v2, s3
    s_lshl_b32 s73, s19, 4
    s_lshr_b32 s93, s93, s73
    s_lshl_b32 s93, s93, 16
    s_lshr_b32 s92, s92, s73
    s_lshl_b32 s92, s92, 16
    v_mov_b32 v204, s92
    v_mul_f32 v204, 0x3fb8aa3b, v204
    v_exp_f32 v204, v204
    v_mov_b32 v16, 1.0
    v_mov_b32 v17, 0
    v_cvt_pk_bf16_f32 v204, v204, v204
    v_lshlrev_b32 v204, 16, v204
    s_waitcnt vmcnt(0)
    v_lshlrev_b32 v208, 16, v208
    v_lshlrev_b32 v209, 16, v209
    v_lshlrev_b32 v210, 16, v210
    v_lshlrev_b32 v211, 16, v211
    v_mul_f32 v208, 0x3fb8aa3b, v208
    v_mul_f32 v209, v209, v204
    v_exp_f32 v208, v208
    v_mul_f32 v209, 0x3e22f983, v209
    v_cvt_pk_bf16_f32 v208, v208, v208
    v_mul_f32 v49, 0x41000000, v209
    v_mul_f32 v51, 0x42800000, v209
    v_mul_f32 v53, 0x3f800000, v209
    v_mul_f32 v55, 0x43800000, v209
    v_mul_f32 v57, 0x44800000, v209
    v_lshlrev_b32 v208, 16, v208
    v_fract_f32 v49, v49
    v_fract_f32 v51, v51
    v_fract_f32 v53, v53
    v_fract_f32 v55, v55
    v_fract_f32 v57, v57
    v_mul_f32 v208, v208, v204
    v_add_f32 v204, v204, v204
    v_mul_f32 v48, 0xc138aa3b, v208
    v_mul_f32 v50, 0xc2b8aa3b, v208
    v_mul_f32 v52, 0xbfb8aa3b, v208
    v_mul_f32 v54, 0xc3b8aa3b, v208
    v_mul_f32 v56, 0xc4b8aa3b, v208
    v_pk_mul_f32 v[210:211], v[210:211], v[204:205] op_sel_hi:[1,0]
    v_cos_f32 v18, v49
    v_sin_f32 v19, v49
    v_exp_f32 v48, v48
    v_cos_f32 v34, v51
    v_sin_f32 v35, v51
    v_exp_f32 v50, v50
    v_cos_f32 v32, v53
    v_sin_f32 v33, v53
    v_exp_f32 v52, v52
    v_cos_f32 v40, v55
    v_sin_f32 v41, v55
    v_exp_f32 v54, v54
    v_cos_f32 v46, v57
    v_sin_f32 v47, v57
    v_exp_f32 v56, v56
    v_pk_mul_f32 v[18:19], v[18:19], v[48:49] op_sel_hi:[1,0]
    v_pk_mul_f32 v[34:35], v[34:35], v[50:51] op_sel_hi:[1,0]
    v_pk_mul_f32 v[32:33], v[32:33], v[52:53] op_sel_hi:[1,0]
    v_pk_mul_f32 v[40:41], v[40:41], v[54:55] op_sel_hi:[1,0]
    v_pk_mul_f32 v[46:47], v[46:47], v[56:57] op_sel_hi:[1,0]
    v_pk_mul_f32 v[20:21], v[18:19], v[18:19] op_sel_hi:[1,0]
    v_pk_mul_f32 v[36:37], v[34:35], v[34:35] op_sel_hi:[1,0]
    v_pk_fma_f32 v[20:21], v[18:19], v[18:19], v[20:21] op_sel:[1,1,0] op_sel_hi:[0,1,1] neg_lo:[1,0,0]
    v_pk_fma_f32 v[36:37], v[34:35], v[34:35], v[36:37] op_sel:[1,1,0] op_sel_hi:[0,1,1] neg_lo:[1,0,0]
    v_pk_mul_f32 v[22:23], v[20:21], v[18:19] op_sel_hi:[1,0]
    v_pk_mul_f32 v[24:25], v[20:21], v[20:21] op_sel_hi:[1,0]
    v_pk_fma_f32 v[22:23], v[20:21], v[18:19], v[22:23] op_sel:[1,1,0] op_sel_hi:[0,1,1] neg_lo:[1,0,0]
    v_pk_fma_f32 v[24:25], v[20:21], v[20:21], v[24:25] op_sel:[1,1,0] op_sel_hi:[0,1,1] neg_lo:[1,0,0]
    v_pk_mul_f32 v[26:27], v[24:25], v[18:19] op_sel_hi:[1,0]
    v_pk_mul_f32 v[28:29], v[24:25], v[20:21] op_sel_hi:[1,0]
    v_pk_mul_f32 v[30:31], v[24:25], v[22:23] op_sel_hi:[1,0]
    v_pk_fma_f32 v[26:27], v[24:25], v[18:19], v[26:27] op_sel:[1,1,0] op_sel_hi:[0,1,1] neg_lo:[1,0,0]
    v_pk_fma_f32 v[28:29], v[24:25], v[20:21], v[28:29] op_sel:[1,1,0] op_sel_hi:[0,1,1] neg_lo:[1,0,0]
    v_pk_fma_f32 v[30:31], v[24:25], v[22:23], v[30:31] op_sel:[1,1,0] op_sel_hi:[0,1,1] neg_lo:[1,0,0]
    v_cvt_pk_bf16_f32 v104, v16, v18
    v_cvt_pk_bf16_f32 v105, v20, v22
    v_cvt_pk_bf16_f32 v106, v24, v26
    v_cvt_pk_bf16_f32 v107, v28, v30
    ds_write_b128 v200, v[104:107] offset:0
    v_cvt_pk_bf16_f32 v108, v17, v19
    v_cvt_pk_bf16_f32 v109, v21, v23
    v_cvt_pk_bf16_f32 v110, v25, v27
    v_cvt_pk_bf16_f32 v111, v29, v31
    v_pk_mul_f32 v[50:51], v[18:19], v[34:35] op_sel_hi:[1,0]
    v_pk_mul_f32 v[52:53], v[20:21], v[34:35] op_sel_hi:[1,0]
    v_pk_mul_f32 v[54:55], v[22:23], v[34:35] op_sel_hi:[1,0]
    ds_write_b128 v200, v[108:111] offset:1024
    v_pk_mul_f32 v[56:57], v[24:25], v[34:35] op_sel_hi:[1,0]
    v_pk_mul_f32 v[58:59], v[26:27], v[34:35] op_sel_hi:[1,0]
    v_pk_mul_f32 v[60:61], v[28:29], v[34:35] op_sel_hi:[1,0]
    v_pk_mul_f32 v[62:63], v[30:31], v[34:35] op_sel_hi:[1,0]
    v_pk_mul_f32 v[38:39], v[36:37], v[34:35] op_sel_hi:[1,0]
    v_pk_fma_f32 v[50:51], v[18:19], v[34:35], v[50:51] op_sel:[1,1,0] op_sel_hi:[0,1,1] neg_lo:[1,0,0]
    v_pk_fma_f32 v[52:53], v[20:21], v[34:35], v[52:53] op_sel:[1,1,0] op_sel_hi:[0,1,1] neg_lo:[1,0,0]
    v_pk_fma_f32 v[54:55], v[22:23], v[34:35], v[54:55] op_sel:[1,1,0] op_sel_hi:[0,1,1] neg_lo:[1,0,0]
    v_pk_fma_f32 v[56:57], v[24:25], v[34:35], v[56:57] op_sel:[1,1,0] op_sel_hi:[0,1,1] neg_lo:[1,0,0]
    v_pk_fma_f32 v[58:59], v[26:27], v[34:35], v[58:59] op_sel:[1,1,0] op_sel_hi:[0,1,1] neg_lo:[1,0,0]
    v_pk_fma_f32 v[60:61], v[28:29], v[34:35], v[60:61] op_sel:[1,1,0] op_sel_hi:[0,1,1] neg_lo:[1,0,0]
    v_pk_fma_f32 v[62:63], v[30:31], v[34:35], v[62:63] op_sel:[1,1,0] op_sel_hi:[0,1,1] neg_lo:[1,0,0]
    v_pk_fma_f32 v[38:39], v[36:37], v[34:35], v[38:39] op_sel:[1,1,0] op_sel_hi:[0,1,1] neg_lo:[1,0,0]
    v_cvt_pk_bf16_f32 v112, v34, v50
    v_cvt_pk_bf16_f32 v113, v52, v54
    v_cvt_pk_bf16_f32 v114, v56, v58
    v_cvt_pk_bf16_f32 v115, v60, v62
    ds_write_b128 v200, v[112:115] offset:2112
    v_cvt_pk_bf16_f32 v116, v35, v51
    v_cvt_pk_bf16_f32 v117, v53, v55
    v_cvt_pk_bf16_f32 v118, v57, v59
    v_cvt_pk_bf16_f32 v119, v61, v63
    v_pk_mul_f32 v[70:71], v[18:19], v[36:37] op_sel_hi:[1,0]
    v_pk_mul_f32 v[72:73], v[20:21], v[36:37] op_sel_hi:[1,0]
    v_pk_mul_f32 v[74:75], v[22:23], v[36:37] op_sel_hi:[1,0]
    ds_write_b128 v200, v[116:119] offset:3136
    v_pk_mul_f32 v[76:77], v[24:25], v[36:37] op_sel_hi:[1,0]
    ds_read_b64_tr_b16 v[160:161], v201 offset:0
    v_pk_mul_f32 v[78:79], v[26:27], v[36:37] op_sel_hi:[1,0]
    ds_read_b64_tr_b16 v[162:163], v201 offset:64
    v_pk_mul_f32 v[80:81], v[28:29], v[36:37] op_sel_hi:[1,0]
    ds_read_b64_tr_b16 v[164:165], v201 offset:512
    v_pk_mul_f32 v[82:83], v[30:31], v[36:37] op_sel_hi:[1,0]
    ds_read_b64_tr_b16 v[166:167], v201 offset:576
    v_pk_mul_f32 v[90:91], v[210:211], v[32:33] op_sel_hi:[1,0]
    ds_read_b64_tr_b16 v[168:169], v201 offset:1024
    v_pk_mul_f32 v[64:65], v[32:33], v[32:33] op_sel_hi:[1,0]
    ds_read_b64_tr_b16 v[170:171], v201 offset:1088
    v_pk_fma_f32 v[70:71], v[18:19], v[36:37], v[70:71] op_sel:[1,1,0] op_sel_hi:[0,1,1] neg_lo:[1,0,0]
    ds_read_b64_tr_b16 v[172:173], v201 offset:1536
    v_pk_fma_f32 v[72:73], v[20:21], v[36:37], v[72:73] op_sel:[1,1,0] op_sel_hi:[0,1,1] neg_lo:[1,0,0]
    ds_read_b64_tr_b16 v[174:175], v201 offset:1600
    v_pk_fma_f32 v[74:75], v[22:23], v[36:37], v[74:75] op_sel:[1,1,0] op_sel_hi:[0,1,1] neg_lo:[1,0,0]
    v_pk_fma_f32 v[76:77], v[24:25], v[36:37], v[76:77] op_sel:[1,1,0] op_sel_hi:[0,1,1] neg_lo:[1,0,0]
    v_pk_fma_f32 v[78:79], v[26:27], v[36:37], v[78:79] op_sel:[1,1,0] op_sel_hi:[0,1,1] neg_lo:[1,0,0]
    v_pk_fma_f32 v[80:81], v[28:29], v[36:37], v[80:81] op_sel:[1,1,0] op_sel_hi:[0,1,1] neg_lo:[1,0,0]
    v_pk_fma_f32 v[82:83], v[30:31], v[36:37], v[82:83] op_sel:[1,1,0] op_sel_hi:[0,1,1] neg_lo:[1,0,0]
    v_pk_fma_f32 v[90:91], v[210:211], v[32:33], v[90:91] op_sel:[1,1,0] op_sel_hi:[0,1,1] neg_lo:[1,0,0]
    v_pk_fma_f32 v[64:65], v[32:33], v[32:33], v[64:65] op_sel:[1,1,0] op_sel_hi:[0,1,1] neg_lo:[1,0,0]
    v_cvt_pk_bf16_f32 v120, v36, v70
    v_cvt_pk_bf16_f32 v121, v72, v74
    v_cvt_pk_bf16_f32 v122, v76, v78
    v_cvt_pk_bf16_f32 v123, v80, v82
    ds_write_b128 v200, v[120:123] offset:0
    v_cvt_pk_bf16_f32 v124, v37, v71
    v_cvt_pk_bf16_f32 v125, v73, v75
    v_cvt_pk_bf16_f32 v126, v77, v79
    v_cvt_pk_bf16_f32 v127, v81, v83
    v_pk_mul_f32 v[50:51], v[18:19], v[38:39] op_sel_hi:[1,0]
    v_pk_mul_f32 v[52:53], v[20:21], v[38:39] op_sel_hi:[1,0]
    v_pk_mul_f32 v[54:55], v[22:23], v[38:39] op_sel_hi:[1,0]
    ds_write_b128 v200, v[124:127] offset:1024
    v_pk_mul_f32 v[56:57], v[24:25], v[38:39] op_sel_hi:[1,0]
    v_pk_mul_f32 v[58:59], v[26:27], v[38:39] op_sel_hi:[1,0]
    v_pk_mul_f32 v[60:61], v[28:29], v[38:39] op_sel_hi:[1,0]
    v_pk_mul_f32 v[62:63], v[30:31], v[38:39] op_sel_hi:[1,0]
    v_pk_mul_f32 v[92:93], v[210:211], v[64:65] op_sel_hi:[1,0]
    v_pk_mul_f32 v[94:95], v[90:91], v[64:65] op_sel_hi:[1,0]
    v_pk_fma_f32 v[50:51], v[18:19], v[38:39], v[50:51] op_sel:[1,1,0] op_sel_hi:[0,1,1] neg_lo:[1,0,0]
    v_pk_fma_f32 v[52:53], v[20:21], v[38:39], v[52:53] op_sel:[1,1,0] op_sel_hi:[0,1,1] neg_lo:[1,0,0]
    v_pk_fma_f32 v[54:55], v[22:23], v[38:39], v[54:55] op_sel:[1,1,0] op_sel_hi:[0,1,1] neg_lo:[1,0,0]
    v_pk_fma_f32 v[56:57], v[24:25], v[38:39], v[56:57] op_sel:[1,1,0] op_sel_hi:[0,1,1] neg_lo:[1,0,0]
    v_pk_fma_f32 v[58:59], v[26:27], v[38:39], v[58:59] op_sel:[1,1,0] op_sel_hi:[0,1,1] neg_lo:[1,0,0]
    v_pk_fma_f32 v[60:61], v[28:29], v[38:39], v[60:61] op_sel:[1,1,0] op_sel_hi:[0,1,1] neg_lo:[1,0,0]
    v_pk_fma_f32 v[62:63], v[30:31], v[38:39], v[62:63] op_sel:[1,1,0] op_sel_hi:[0,1,1] neg_lo:[1,0,0]
    v_pk_fma_f32 v[92:93], v[210:211], v[64:65], v[92:93] op_sel:[1,1,0] op_sel_hi:[0,1,1] neg_lo:[1,0,0]
    v_pk_fma_f32 v[94:95], v[90:91], v[64:65], v[94:95] op_sel:[1,1,0] op_sel_hi:[0,1,1] neg_lo:[1,0,0]
    v_cvt_pk_bf16_f32 v104, v38, v50
    v_cvt_pk_bf16_f32 v105, v52, v54
    v_cvt_pk_bf16_f32 v106, v56, v58
    v_cvt_pk_bf16_f32 v107, v60, v62
    ds_write_b128 v200, v[104:107] offset:2112
    v_cvt_pk_bf16_f32 v108, v39, v51
    v_cvt_pk_bf16_f32 v109, v53, v55
    v_cvt_pk_bf16_f32 v110, v57, v59
    v_cvt_pk_bf16_f32 v111, v61, v63
    v_pk_mul_f32 v[96:97], v[92:93], v[64:65] op_sel_hi:[1,0]
    v_pk_mul_f32 v[98:99], v[94:95], v[64:65] op_sel_hi:[1,0]
    v_pk_mul_f32 v[42:43], v[40:41], v[40:41] op_sel_hi:[1,0]
    ds_write_b128 v200, v[108:111] offset:3136
    v_pk_mul_f32 v[66:67], v[210:211], v[46:47] op_sel_hi:[1,0]
    ds_read_b64_tr_b16 v[176:177], v201 offset:0
    v_pk_fma_f32 v[96:97], v[92:93], v[64:65], v[96:97] op_sel:[1,1,0] op_sel_hi:[0,1,1] neg_lo:[1,0,0]
    ds_read_b64_tr_b16 v[178:179], v201 offset:64
    v_pk_fma_f32 v[98:99], v[94:95], v[64:65], v[98:99] op_sel:[1,1,0] op_sel_hi:[0,1,1] neg_lo:[1,0,0]
    ds_read_b64_tr_b16 v[180:181], v201 offset:512
    v_pk_fma_f32 v[42:43], v[40:41], v[40:41], v[42:43] op_sel:[1,1,0] op_sel_hi:[0,1,1] neg_lo:[1,0,0]
    ds_read_b64_tr_b16 v[182:183], v201 offset:576
    v_pk_fma_f32 v[66:67], v[210:211], v[46:47], v[66:67] op_sel:[1,1,0] op_sel_hi:[0,1,1] neg_lo:[1,0,0]
    ds_read_b64_tr_b16 v[184:185], v201 offset:1024
    v_pk_mul_f32 v[100:101], v[96:97], v[64:65] op_sel_hi:[1,0]
    ds_read_b64_tr_b16 v[186:187], v201 offset:1088
    v_pk_mul_f32 v[102:103], v[98:99], v[64:65] op_sel_hi:[1,0]
    ds_read_b64_tr_b16 v[188:189], v201 offset:1536
    v_pk_mul_f32 v[44:45], v[42:43], v[40:41] op_sel_hi:[1,0]
    ds_read_b64_tr_b16 v[190:191], v201 offset:1600
    v_pk_fma_f32 v[100:101], v[96:97], v[64:65], v[100:101] op_sel:[1,1,0] op_sel_hi:[0,1,1] neg_lo:[1,0,0]
    v_pk_fma_f32 v[102:103], v[98:99], v[64:65], v[102:103] op_sel:[1,1,0] op_sel_hi:[0,1,1] neg_lo:[1,0,0]
    v_pk_fma_f32 v[44:45], v[42:43], v[40:41], v[44:45] op_sel:[1,1,0] op_sel_hi:[0,1,1] neg_lo:[1,0,0]
    v_cvt_pk_bf16_f32 v112, v210, v90
    v_cvt_pk_bf16_f32 v113, v92, v94
    v_cvt_pk_bf16_f32 v114, v96, v98
    v_cvt_pk_bf16_f32 v115, v100, v102
    ds_write_b128 v200, v[112:115] offset:0
    v_cvt_pk_bf16_f32 v116, -v211, -v91
    v_cvt_pk_bf16_f32 v117, -v93, -v95
    v_cvt_pk_bf16_f32 v118, -v97, -v99
    v_cvt_pk_bf16_f32 v119, -v101, -v103
    v_pk_mul_f32 v[68:69], v[210:211], v[40:41] op_sel_hi:[1,0]
    v_pk_mul_f32 v[70:71], v[92:93], v[40:41] op_sel_hi:[1,0]
    v_pk_mul_f32 v[72:73], v[96:97], v[40:41] op_sel_hi:[1,0]
    ds_write_b128 v200, v[116:119] offset:1024
    v_pk_mul_f32 v[74:75], v[100:101], v[40:41] op_sel_hi:[1,0]
    v_pk_mul_f32 v[76:77], v[210:211], v[42:43] op_sel_hi:[1,0]
    v_pk_mul_f32 v[78:79], v[96:97], v[42:43] op_sel_hi:[1,0]
    v_pk_mul_f32 v[80:81], v[210:211], v[44:45] op_sel_hi:[1,0]
    v_pk_mul_f32 v[82:83], v[96:97], v[44:45] op_sel_hi:[1,0]
    v_pk_fma_f32 v[68:69], v[210:211], v[40:41], v[68:69] op_sel:[1,1,0] op_sel_hi:[0,1,1] neg_lo:[1,0,0]
    v_pk_fma_f32 v[70:71], v[92:93], v[40:41], v[70:71] op_sel:[1,1,0] op_sel_hi:[0,1,1] neg_lo:[1,0,0]
    v_pk_fma_f32 v[72:73], v[96:97], v[40:41], v[72:73] op_sel:[1,1,0] op_sel_hi:[0,1,1] neg_lo:[1,0,0]
    v_pk_fma_f32 v[74:75], v[100:101], v[40:41], v[74:75] op_sel:[1,1,0] op_sel_hi:[0,1,1] neg_lo:[1,0,0]
    v_pk_fma_f32 v[76:77], v[210:211], v[42:43], v[76:77] op_sel:[1,1,0] op_sel_hi:[0,1,1] neg_lo:[1,0,0]
    v_pk_fma_f32 v[78:79], v[96:97], v[42:43], v[78:79] op_sel:[1,1,0] op_sel_hi:[0,1,1] neg_lo:[1,0,0]
    v_pk_fma_f32 v[80:81], v[210:211], v[44:45], v[80:81] op_sel:[1,1,0] op_sel_hi:[0,1,1] neg_lo:[1,0,0]
    v_pk_fma_f32 v[82:83], v[96:97], v[44:45], v[82:83] op_sel:[1,1,0] op_sel_hi:[0,1,1] neg_lo:[1,0,0]
    v_cvt_pk_bf16_f32 v120, v68, v70
    v_cvt_pk_bf16_f32 v121, v72, v74
    v_cvt_pk_bf16_f32 v122, v76, v78
    v_cvt_pk_bf16_f32 v123, v80, v82
    ds_write_b128 v200, v[120:123] offset:2112
    v_cvt_pk_bf16_f32 v124, -v69, -v71
    v_cvt_pk_bf16_f32 v125, -v73, -v75
    v_cvt_pk_bf16_f32 v126, -v77, -v79
    v_cvt_pk_bf16_f32 v127, -v81, -v83
    v_pk_mul_f32 v[18:19], v[66:67], v[40:41] op_sel_hi:[1,0]
    v_pk_mul_f32 v[20:21], v[66:67], v[42:43] op_sel_hi:[1,0]
    v_pk_mul_f32 v[22:23], v[66:67], v[44:45] op_sel_hi:[1,0]
    ds_write_b128 v200, v[124:127] offset:3136
    v_pk_mul_f32 v[24:25], v[66:67], v[46:47] op_sel_hi:[1,0]
    v_pk_fma_f32 v[18:19], v[66:67], v[40:41], v[18:19] op_sel:[1,1,0] op_sel_hi:[0,1,1] neg_lo:[1,0,0]
    v_pk_fma_f32 v[20:21], v[66:67], v[42:43], v[20:21] op_sel:[1,1,0] op_sel_hi:[0,1,1] neg_lo:[1,0,0]
    v_pk_fma_f32 v[22:23], v[66:67], v[44:45], v[22:23] op_sel:[1,1,0] op_sel_hi:[0,1,1] neg_lo:[1,0,0]
    v_pk_fma_f32 v[24:25], v[66:67], v[46:47], v[24:25] op_sel:[1,1,0] op_sel_hi:[0,1,1] neg_lo:[1,0,0]
    ds_read_b64_tr_b16 v[216:217], v201 offset:0
    ds_read_b64_tr_b16 v[218:219], v201 offset:64
    ds_read_b64_tr_b16 v[220:221], v201 offset:512
    ds_read_b64_tr_b16 v[222:223], v201 offset:576
    ds_read_b64_tr_b16 v[224:225], v201 offset:1024
    ds_read_b64_tr_b16 v[226:227], v201 offset:1088
    ds_read_b64_tr_b16 v[228:229], v201 offset:1536
    ds_read_b64_tr_b16 v[230:231], v201 offset:1600
    v_cvt_pk_bf16_f32 v104, v66, v18
    v_cvt_pk_bf16_f32 v105, v20, v22
    v_cvt_pk_bf16_f32 v106, v24, v26
    v_cvt_pk_bf16_f32 v107, v28, v30
    ds_write_b128 v200, v[104:107] offset:0
    v_cvt_pk_bf16_f32 v108, -v67, -v19
    v_cvt_pk_bf16_f32 v109, -v21, -v23
    v_cvt_pk_bf16_f32 v110, -v25, -v27
    v_cvt_pk_bf16_f32 v111, -v29, -v31
    ds_write_b128 v200, v[108:111] offset:1024
    ds_read_b64_tr_b16 v[232:233], v201 offset:0
    ds_read_b64_tr_b16 v[234:235], v201 offset:64
    ds_read_b64_tr_b16 v[236:237], v201 offset:512
    ds_read_b64_tr_b16 v[238:239], v201 offset:576
    ds_read_b64_tr_b16 v[240:241], v201 offset:1024
    ds_read_b64_tr_b16 v[242:243], v201 offset:1088
    ds_read_b64_tr_b16 v[244:245], v201 offset:1536
    ds_read_b64_tr_b16 v[246:247], v201 offset:1600
    ds_read_b128 v[208:211], v11 offset:16
    s_waitcnt lgkmcnt(15)
    v_mfma_f32_16x16x32_bf16 v[144:147], v[160:163], v[216:219], 0
    v_mfma_f32_16x16x32_bf16 v[148:151], v[176:179], v[216:219], 0
    v_mfma_f32_16x16x32_bf16 v[144:147], v[164:167], v[220:223], v[144:147]
    v_mfma_f32_16x16x32_bf16 v[148:151], v[180:183], v[220:223], v[148:151]
    s_waitcnt lgkmcnt(13)
    v_mfma_f32_16x16x32_bf16 v[144:147], v[168:171], v[224:227], v[144:147]
    v_mfma_f32_16x16x32_bf16 v[148:151], v[184:187], v[224:227], v[148:151]
    s_waitcnt lgkmcnt(11)
    v_mfma_f32_16x16x32_bf16 v[144:147], v[172:175], v[228:231], v[144:147]
    v_mfma_f32_16x16x32_bf16 v[148:151], v[188:191], v[228:231], v[148:151]
    s_waitcnt lgkmcnt(7)
    v_mfma_f32_16x16x32_bf16 v[152:155], v[160:163], v[232:235], 0
    v_mfma_f32_16x16x32_bf16 v[156:159], v[176:179], v[232:235], 0
    s_waitcnt lgkmcnt(5)
    v_mfma_f32_16x16x32_bf16 v[152:155], v[164:167], v[236:239], v[152:155]
    v_mfma_f32_16x16x32_bf16 v[156:159], v[180:183], v[236:239], v[156:159]
    s_waitcnt lgkmcnt(3)
    v_mfma_f32_16x16x32_bf16 v[152:155], v[168:171], v[240:243], v[152:155]
    v_mfma_f32_16x16x32_bf16 v[156:159], v[184:187], v[240:243], v[156:159]
    s_waitcnt lgkmcnt(1)
    v_mfma_f32_16x16x32_bf16 v[152:155], v[172:175], v[244:247], v[152:155]
    v_mfma_f32_16x16x32_bf16 v[156:159], v[188:191], v[244:247], v[156:159]
    s_waitcnt lgkmcnt(0)
    v_min_u32 v208, v208, v209
    v_min3_u32 v208, v208, v210, v211
    v_cmp_gt_u32 vcc, 1, v208
    s_nop 4
    s_cbranch_vccnz Lretry0
Ldone0:
    ds_write_b32 v203, v9 offset:3168
    ds_write_b128 v202, v[144:147] offset:0
    ds_write_b128 v202, v[148:151] offset:64
    ds_write_b128 v206, v[152:155] offset:2304
    ds_write_b128 v206, v[156:159] offset:2368
    v_bfe_u32 v18, v1, 2, 2
    v_and_b32 v140, 15, v1
    v_lshrrev_b32 v141, 4, v1
    v_bfe_u32 v20, v1, 1, 3
    v_xor_b32 v20, v20, v141
    s_lshl_b32 s71, s19, 14
    v_lshl_add_u32 v21, v140, 7, s71
    v_lshl_add_u32 v128, v20, 4, v21
    v_xor_b32 v129, 64, v128
    v_add_u32 v130, 0x10000, v128
    v_add_u32 v131, 0x10000, v129
    s_and_b32 s95, s67, 1
    s_lshl_b32 s95, s95, 1
    v_xor_b32 v21, s95, v18
    v_lshlrev_b32 v21, 6, v21
    v_lshl_add_u32 v21, v18, 8, v21
    v_lshl_add_u32 v21, v141, 12, v21
    v_bfe_u32 v22, v1, 1, 1
    v_lshl_add_u32 v21, v22, 5, v21
    v_and_b32 v22, 1, v1
    v_lshl_add_u32 v21, v22, 3, v21
    v_and_b32 v22, 1, v141
    v_lshl_add_u32 v21, v22, 4, v21
    v_add_u32 v132, 2048, v21
    v_xor_b32 v133, 16, v132
    v_xor_b32 v134, 64, v132
    v_xor_b32 v135, 80, v132
    v_add_u32 v136, 0x10000, v132
    v_add_u32 v137, 0x10000, v133
    v_add_u32 v138, 0x10000, v134
    v_add_u32 v139, 0x10000, v135
    v_bfe_u32 v20, v1, 3, 1
    v_and_b32 v21, 7, v1
    v_lshl_add_u32 v21, v20, 4, v21
    v_lshl_add_u32 v21, v22, 3, v21
    v_lshrrev_b32 v20, 5, v1
    v_lshl_add_u32 v21, v20, 5, v21
    s_lshl_b32 s72, s64, 2
    s_add_u32 s72, s72, s95
    s_lshl_b32 s72, s72, 5
    v_add_u32 v143, s72, v21
    v_lshlrev_b32 v142, 1, v143
    buffer_load_ushort v142, v142, s[56:59], 0 offen
    s_and_b32 s71, s61, 3
    s_lshl_b32 s71, s71, 1
    s_add_u32 s70, s66, s71
    s_sub_u32 s71, s70, 7
    s_min_u32 s70, s70, s71
    s_lshl_b32 s76, s70, 12
    s_add_u32 s70, s76, 4096
    s_sub_u32 s71, s70, 28672
    s_min_u32 s77, s70, s71
    s_add_u32 s70, s76, 8192
    s_sub_u32 s71, s70, 28672
    s_min_u32 s78, s70, s71
    s_add_u32 s70, s76, 12288
    s_sub_u32 s71, s70, 28672
    s_min_u32 s79, s70, s71
    s_add_u32 s70, s76, 16384
    s_sub_u32 s71, s70, 28672
    s_min_u32 s80, s70, s71
    s_add_u32 s70, s76, 20480
    s_sub_u32 s71, s70, 28672
    s_min_u32 s81, s70, s71
    s_add_u32 s70, s76, 24576
    s_sub_u32 s71, s70, 28672
    s_min_u32 s82, s70, s71
    s_lshr_b32 s83, s76, 2
    s_lshr_b32 s84, s77, 2
    s_lshr_b32 s85, s78, 2
    s_lshr_b32 s86, s79, 2
    s_lshr_b32 s87, s80, 2
    s_lshr_b32 s88, s81, 2
    s_lshr_b32 s89, s82, 2
    s_and_b32 s96, s66, 1
    s_lshl_b32 s96, s96, 2
    s_xor_b32 s96, s96, s67
    s_mul_i32 s71, s96, 28672
    s_mul_i32 s70, s66, 229376
    s_add_u32 s70, s70, s71
    s_add_u32 s70, s70, 3407872
    v_add_u32 v4, s70, v3
    s_mul_i32 s70, s65, 229376
    s_lshr_b32 s71, s71, 2
    s_add_u32 s70, s70, s71
    s_add_u32 s70, s70, 7602176
    v_add_u32 v5, s70, v3
    s_lshr_b32 s70, s96, 2
    s_lshl_b32 s71, s65, 2
    s_add_u32 s70, s70, s71
    s_lshl_b32 s70, s70, 7
    s_add_u32 s48, s70, 786432
    s_add_u32 s49, s48, 256
    v_lshlrev_b32 v143, 5, v143
    v_add_u32 v143, 32768, v143
    s_lshl_b32 s72, s63, 1
    s_add_u32 s18, s72, s19
    s_lshl_b32 s72, s18, 9
    s_add_u32 s72, s72, 16384
    v_lshl_add_u32 v140, v140, 3, s72
    s_mul_i32 s70, s18, 224
    s_lshl_b32 s71, s64, 2
    s_add_u32 s70, s70, s71
    s_add_u32 s70, s70, s95
    s_lshl_b32 s70, s70, 10
    s_add_u32 s32, s70, 7602176
    s_lshl_b32 s71, s18, 2
    s_and_b32 s72, s60, 1
    s_add_u32 s71, s71, s72
    s_lshl_b32 s71, s71, 7
    s_add_u32 s29, s71, 786432
    v_mov_b32 v218, 0
    v_mov_b32 v219, 0
    v_mov_b32 v234, 0
    v_mov_b32 v235, 0
    v_cmp_eq_u32 s[6:7], 0, v141
    v_mov_b32 v222, 0
    v_mov_b32 v223, 0
    v_mov_b32 v238, 0
    v_mov_b32 v239, 0
    v_cmp_eq_u32 s[8:9], 1, v141
    v_mov_b32 v226, 0
    v_mov_b32 v227, 0
    v_mov_b32 v242, 0
    v_mov_b32 v243, 0
    v_cmp_eq_u32 s[10:11], 2, v141
    v_mov_b32 v230, 0
    v_mov_b32 v231, 0
    v_mov_b32 v246, 0
    v_mov_b32 v247, 0
    v_cmp_eq_u32 s[12:13], 3, v141
    s_waitcnt lgkmcnt(0)
    s_barrier
    s_cmp_ge_u32 s61, 28
    s_nop 1
    s_cbranch_scc1 LXspare
    ds_read_b64_tr_b16 v[80:81], v136 offset:32768
    ds_read_b64_tr_b16 v[82:83], v136 offset:33792
    ds_read_b128 v[96:99], v130 offset:32768
    ds_read_b64_tr_b16 v[84:85], v137 offset:32768
    ds_read_b64_tr_b16 v[86:87], v137 offset:33792
    ds_read_b128 v[100:103], v130 offset:36864
    ds_read_b64_tr_b16 v[88:89], v138 offset:32768
    ds_read_b64_tr_b16 v[90:91], v138 offset:33792
    ds_read_b128 v[104:107], v130 offset:40960
    ds_read_b64_tr_b16 v[92:93], v139 offset:32768
    ds_read_b64_tr_b16 v[94:95], v139 offset:33792
    ds_read_b128 v[108:111], v130 offset:45056
    s_waitcnt lgkmcnt(9)
    v_mfma_f32_16x16x32_bf16 v[16:19], v[80:83], v[96:99], 0
    s_waitcnt lgkmcnt(6)
    v_mfma_f32_16x16x32_bf16 v[32:35], v[80:83], v[100:103], 0
    v_mfma_f32_16x16x32_bf16 v[20:23], v[84:87], v[96:99], 0
    v_mfma_f32_16x16x32_bf16 v[36:39], v[84:87], v[100:103], 0
    s_waitcnt lgkmcnt(3)
    v_mfma_f32_16x16x32_bf16 v[48:51], v[80:83], v[104:107], 0
    ds_read_b64_tr_b16 v[144:145], v136 offset:49152
    ds_read_b64_tr_b16 v[146:147], v136 offset:50176
    v_mfma_f32_16x16x32_bf16 v[52:55], v[84:87], v[104:107], 0
    ds_read_b128 v[160:163], v131 offset:32768
    ds_read_b64_tr_b16 v[148:149], v137 offset:49152
    v_mfma_f32_16x16x32_bf16 v[24:27], v[88:91], v[96:99], 0
    ds_read_b64_tr_b16 v[150:151], v137 offset:50176
    ds_read_b128 v[164:167], v131 offset:36864
    v_mfma_f32_16x16x32_bf16 v[40:43], v[88:91], v[100:103], 0
    ds_read_b64_tr_b16 v[152:153], v138 offset:49152
    ds_read_b64_tr_b16 v[154:155], v138 offset:50176
    v_mfma_f32_16x16x32_bf16 v[56:59], v[88:91], v[104:107], 0
    ds_read_b128 v[168:171], v131 offset:40960
    ds_read_b64_tr_b16 v[156:157], v139 offset:49152
    s_waitcnt lgkmcnt(10)
    v_mfma_f32_16x16x32_bf16 v[64:67], v[80:83], v[108:111], 0
    ds_read_b64_tr_b16 v[158:159], v139 offset:50176
    ds_read_b128 v[172:175], v131 offset:45056
    v_mfma_f32_16x16x32_bf16 v[68:71], v[84:87], v[108:111], 0
    v_mfma_f32_16x16x32_bf16 v[72:75], v[88:91], v[108:111], 0
    v_mfma_f32_16x16x32_bf16 v[28:31], v[92:95], v[96:99], 0
    v_mfma_f32_16x16x32_bf16 v[44:47], v[92:95], v[100:103], 0
    v_mfma_f32_16x16x32_bf16 v[60:63], v[92:95], v[104:107], 0
    v_mfma_f32_16x16x32_bf16 v[76:79], v[92:95], v[108:111], 0
    s_waitcnt lgkmcnt(0)
    v_mfma_f32_16x16x32_bf16 v[16:19], v[144:147], v[160:163], v[16:19]
    v_mfma_f32_16x16x32_bf16 v[32:35], v[144:147], v[164:167], v[32:35]
    s_waitcnt lgkmcnt(0)
    s_barrier
    ds_read_b64_tr_b16 v[80:81], v132 offset:0
    ds_read_b64_tr_b16 v[82:83], v132 offset:1024
    v_mfma_f32_16x16x32_bf16 v[20:23], v[148:151], v[160:163], v[20:23]
    ds_read_b128 v[96:99], v128 offset:0
    ds_read_b64_tr_b16 v[84:85], v133 offset:0
    v_mfma_f32_16x16x32_bf16 v[36:39], v[148:151], v[164:167], v[36:39]
    ds_read_b64_tr_b16 v[86:87], v133 offset:1024
    ds_read_b128 v[100:103], v128 offset:4096
    v_mfma_f32_16x16x32_bf16 v[48:51], v[144:147], v[168:171], v[48:51]
    ds_read_b64_tr_b16 v[88:89], v134 offset:0
    ds_read_b64_tr_b16 v[90:91], v134 offset:1024
    v_mfma_f32_16x16x32_bf16 v[52:55], v[148:151], v[168:171], v[52:55]
    ds_read_b128 v[104:107], v128 offset:8192
    ds_read_b64_tr_b16 v[92:93], v135 offset:0
    v_mfma_f32_16x16x32_bf16 v[24:27], v[152:155], v[160:163], v[24:27]
    ds_read_b64_tr_b16 v[94:95], v135 offset:1024
    ds_read_b128 v[108:111], v128 offset:12288
    v_mfma_f32_16x16x32_bf16 v[40:43], v[152:155], v[164:167], v[40:43]
    v_mfma_f32_16x16x32_bf16 v[56:59], v[152:155], v[168:171], v[56:59]
    v_mfma_f32_16x16x32_bf16 v[64:67], v[144:147], v[172:175], v[64:67]
    v_mfma_f32_16x16x32_bf16 v[68:71], v[148:151], v[172:175], v[68:71]
    v_mfma_f32_16x16x32_bf16 v[72:75], v[152:155], v[172:175], v[72:75]
    v_mfma_f32_16x16x32_bf16 v[28:31], v[156:159], v[160:163], v[28:31]
    v_mfma_f32_16x16x32_bf16 v[44:47], v[156:159], v[164:167], v[44:47]
    v_mfma_f32_16x16x32_bf16 v[60:63], v[156:159], v[168:171], v[60:63]
    v_mfma_f32_16x16x32_bf16 v[76:79], v[156:159], v[172:175], v[76:79]
    s_waitcnt lgkmcnt(0)
    v_mfma_f32_16x16x32_bf16 v[16:19], v[80:83], v[96:99], v[16:19]
    ds_read_b64_tr_b16 v[144:145], v132 offset:16384
    ds_read_b64_tr_b16 v[146:147], v132 offset:17408
    v_mfma_f32_16x16x32_bf16 v[32:35], v[80:83], v[100:103], v[32:35]
    ds_read_b128 v[160:163], v129 offset:0
    ds_read_b64_tr_b16 v[148:149], v133 offset:16384
    v_mfma_f32_16x16x32_bf16 v[20:23], v[84:87], v[96:99], v[20:23]
    ds_read_b64_tr_b16 v[150:151], v133 offset:17408
    ds_read_b128 v[164:167], v129 offset:4096
    v_mfma_f32_16x16x32_bf16 v[36:39], v[84:87], v[100:103], v[36:39]
    ds_read_b64_tr_b16 v[152:153], v134 offset:16384
    ds_read_b64_tr_b16 v[154:155], v134 offset:17408
    v_mfma_f32_16x16x32_bf16 v[48:51], v[80:83], v[104:107], v[48:51]
    ds_read_b128 v[168:171], v129 offset:8192
    ds_read_b64_tr_b16 v[156:157], v135 offset:16384
    v_mfma_f32_16x16x32_bf16 v[52:55], v[84:87], v[104:107], v[52:55]
    ds_read_b64_tr_b16 v[158:159], v135 offset:17408
    ds_read_b128 v[172:175], v129 offset:12288
    v_mfma_f32_16x16x32_bf16 v[24:27], v[88:91], v[96:99], v[24:27]
    v_mfma_f32_16x16x32_bf16 v[40:43], v[88:91], v[100:103], v[40:43]
    v_mfma_f32_16x16x32_bf16 v[56:59], v[88:91], v[104:107], v[56:59]
    v_mfma_f32_16x16x32_bf16 v[64:67], v[80:83], v[108:111], v[64:67]
    v_mfma_f32_16x16x32_bf16 v[68:71], v[84:87], v[108:111], v[68:71]
    v_mfma_f32_16x16x32_bf16 v[72:75], v[88:91], v[108:111], v[72:75]
    v_mfma_f32_16x16x32_bf16 v[28:31], v[92:95], v[96:99], v[28:31]
    v_mfma_f32_16x16x32_bf16 v[44:47], v[92:95], v[100:103], v[44:47]
    v_mfma_f32_16x16x32_bf16 v[60:63], v[92:95], v[104:107], v[60:63]
    v_mfma_f32_16x16x32_bf16 v[76:79], v[92:95], v[108:111], v[76:79]
    s_waitcnt lgkmcnt(0)
    v_mfma_f32_16x16x32_bf16 v[16:19], v[144:147], v[160:163], v[16:19]
    v_mfma_f32_16x16x32_bf16 v[32:35], v[144:147], v[164:167], v[32:35]
    s_waitcnt lgkmcnt(0)
    s_barrier
    ds_read_b64_tr_b16 v[80:81], v132 offset:32768
    ds_read_b64_tr_b16 v[82:83], v132 offset:33792
    v_mfma_f32_16x16x32_bf16 v[20:23], v[148:151], v[160:163], v[20:23]
    ds_read_b128 v[96:99], v128 offset:32768
    ds_read_b64_tr_b16 v[84:85], v133 offset:32768
    v_mfma_f32_16x16x32_bf16 v[36:39], v[148:151], v[164:167], v[36:39]
    ds_read_b64_tr_b16 v[86:87], v133 offset:33792
    ds_read_b128 v[100:103], v128 offset:36864
    v_mfma_f32_16x16x32_bf16 v[48:51], v[144:147], v[168:171], v[48:51]
    ds_read_b64_tr_b16 v[88:89], v134 offset:32768
    ds_read_b64_tr_b16 v[90:91], v134 offset:33792
    v_mfma_f32_16x16x32_bf16 v[52:55], v[148:151], v[168:171], v[52:55]
    ds_read_b128 v[104:107], v128 offset:40960
    ds_read_b64_tr_b16 v[92:93], v135 offset:32768
    v_mfma_f32_16x16x32_bf16 v[24:27], v[152:155], v[160:163], v[24:27]
    ds_read_b64_tr_b16 v[94:95], v135 offset:33792
    ds_read_b128 v[108:111], v128 offset:45056
    v_mfma_f32_16x16x32_bf16 v[40:43], v[152:155], v[164:167], v[40:43]
    v_mfma_f32_16x16x32_bf16 v[56:59], v[152:155], v[168:171], v[56:59]
    v_mfma_f32_16x16x32_bf16 v[64:67], v[144:147], v[172:175], v[64:67]
    v_mfma_f32_16x16x32_bf16 v[68:71], v[148:151], v[172:175], v[68:71]
    v_mfma_f32_16x16x32_bf16 v[72:75], v[152:155], v[172:175], v[72:75]
    v_mfma_f32_16x16x32_bf16 v[28:31], v[156:159], v[160:163], v[28:31]
    v_mfma_f32_16x16x32_bf16 v[44:47], v[156:159], v[164:167], v[44:47]
    v_mfma_f32_16x16x32_bf16 v[60:63], v[156:159], v[168:171], v[60:63]
    v_mfma_f32_16x16x32_bf16 v[76:79], v[156:159], v[172:175], v[76:79]
    s_waitcnt lgkmcnt(0)
    v_mfma_f32_16x16x32_bf16 v[16:19], v[80:83], v[96:99], v[16:19]
    ds_read_b64_tr_b16 v[144:145], v132 offset:49152
    ds_read_b64_tr_b16 v[146:147], v132 offset:50176
    v_mfma_f32_16x16x32_bf16 v[32:35], v[80:83], v[100:103], v[32:35]
    ds_read_b128 v[160:163], v129 offset:32768
    ds_read_b64_tr_b16 v[148:149], v133 offset:49152
    v_mfma_f32_16x16x32_bf16 v[20:23], v[84:87], v[96:99], v[20:23]
    ds_read_b64_tr_b16 v[150:151], v133 offset:50176
    ds_read_b128 v[164:167], v129 offset:36864
    v_mfma_f32_16x16x32_bf16 v[36:39], v[84:87], v[100:103], v[36:39]
    ds_read_b64_tr_b16 v[152:153], v134 offset:49152
    ds_read_b64_tr_b16 v[154:155], v134 offset:50176
    v_mfma_f32_16x16x32_bf16 v[48:51], v[80:83], v[104:107], v[48:51]
    ds_read_b128 v[168:171], v129 offset:40960
    ds_read_b64_tr_b16 v[156:157], v135 offset:49152
    v_mfma_f32_16x16x32_bf16 v[52:55], v[84:87], v[104:107], v[52:55]
    ds_read_b64_tr_b16 v[158:159], v135 offset:50176
    ds_read_b128 v[172:175], v129 offset:45056
    v_mfma_f32_16x16x32_bf16 v[24:27], v[88:91], v[96:99], v[24:27]
    v_mfma_f32_16x16x32_bf16 v[40:43], v[88:91], v[100:103], v[40:43]
    v_mfma_f32_16x16x32_bf16 v[56:59], v[88:91], v[104:107], v[56:59]
    v_mfma_f32_16x16x32_bf16 v[64:67], v[80:83], v[108:111], v[64:67]
    v_mfma_f32_16x16x32_bf16 v[68:71], v[84:87], v[108:111], v[68:71]
    v_mfma_f32_16x16x32_bf16 v[72:75], v[88:91], v[108:111], v[72:75]
    v_mfma_f32_16x16x32_bf16 v[28:31], v[92:95], v[96:99], v[28:31]
    v_mfma_f32_16x16x32_bf16 v[44:47], v[92:95], v[100:103], v[44:47]
    v_mfma_f32_16x16x32_bf16 v[60:63], v[92:95], v[104:107], v[60:63]
    v_mfma_f32_16x16x32_bf16 v[76:79], v[92:95], v[108:111], v[76:79]
    s_waitcnt lgkmcnt(0)
    v_mfma_f32_16x16x32_bf16 v[16:19], v[144:147], v[160:163], v[16:19]
    v_mfma_f32_16x16x32_bf16 v[32:35], v[144:147], v[164:167], v[32:35]
    s_waitcnt lgkmcnt(0)
    s_barrier
    ds_read_b64_tr_b16 v[80:81], v136 offset:0
    ds_read_b64_tr_b16 v[82:83], v136 offset:1024
    v_mfma_f32_16x16x32_bf16 v[20:23], v[148:151], v[160:163], v[20:23]
    ds_read_b128 v[96:99], v130 offset:0
    ds_read_b64_tr_b16 v[84:85], v137 offset:0
    v_mfma_f32_16x16x32_bf16 v[36:39], v[148:151], v[164:167], v[36:39]
    ds_read_b64_tr_b16 v[86:87], v137 offset:1024
    ds_read_b128 v[100:103], v130 offset:4096
    v_mfma_f32_16x16x32_bf16 v[48:51], v[144:147], v[168:171], v[48:51]
    ds_read_b64_tr_b16 v[88:89], v138 offset:0
    ds_read_b64_tr_b16 v[90:91], v138 offset:1024
    v_mfma_f32_16x16x32_bf16 v[52:55], v[148:151], v[168:171], v[52:55]
    ds_read_b128 v[104:107], v130 offset:8192
    ds_read_b64_tr_b16 v[92:93], v139 offset:0
    v_mfma_f32_16x16x32_bf16 v[24:27], v[152:155], v[160:163], v[24:27]
    ds_read_b64_tr_b16 v[94:95], v139 offset:1024
    ds_read_b128 v[108:111], v130 offset:12288
    v_mfma_f32_16x16x32_bf16 v[40:43], v[152:155], v[164:167], v[40:43]
    v_mfma_f32_16x16x32_bf16 v[56:59], v[152:155], v[168:171], v[56:59]
    v_mfma_f32_16x16x32_bf16 v[64:67], v[144:147], v[172:175], v[64:67]
    v_mfma_f32_16x16x32_bf16 v[68:71], v[148:151], v[172:175], v[68:71]
    v_mfma_f32_16x16x32_bf16 v[72:75], v[152:155], v[172:175], v[72:75]
    v_mfma_f32_16x16x32_bf16 v[28:31], v[156:159], v[160:163], v[28:31]
    v_mfma_f32_16x16x32_bf16 v[44:47], v[156:159], v[164:167], v[44:47]
    v_mfma_f32_16x16x32_bf16 v[60:63], v[156:159], v[168:171], v[60:63]
    v_mfma_f32_16x16x32_bf16 v[76:79], v[156:159], v[172:175], v[76:79]
    s_waitcnt lgkmcnt(0)
    v_mfma_f32_16x16x32_bf16 v[16:19], v[80:83], v[96:99], v[16:19]
    ds_read_b64_tr_b16 v[144:145], v136 offset:16384
    ds_read_b64_tr_b16 v[146:147], v136 offset:17408
    v_mfma_f32_16x16x32_bf16 v[32:35], v[80:83], v[100:103], v[32:35]
    ds_read_b128 v[160:163], v131 offset:0
    ds_read_b64_tr_b16 v[148:149], v137 offset:16384
    v_mfma_f32_16x16x32_bf16 v[20:23], v[84:87], v[96:99], v[20:23]
    ds_read_b64_tr_b16 v[150:151], v137 offset:17408
    ds_read_b128 v[164:167], v131 offset:4096
    v_mfma_f32_16x16x32_bf16 v[36:39], v[84:87], v[100:103], v[36:39]
    ds_read_b64_tr_b16 v[152:153], v138 offset:16384
    ds_read_b64_tr_b16 v[154:155], v138 offset:17408
    v_mfma_f32_16x16x32_bf16 v[48:51], v[80:83], v[104:107], v[48:51]
    ds_read_b128 v[168:171], v131 offset:8192
    ds_read_b64_tr_b16 v[156:157], v139 offset:16384
    v_mfma_f32_16x16x32_bf16 v[52:55], v[84:87], v[104:107], v[52:55]
    ds_read_b64_tr_b16 v[158:159], v139 offset:17408
    ds_read_b128 v[172:175], v131 offset:12288
    v_mfma_f32_16x16x32_bf16 v[24:27], v[88:91], v[96:99], v[24:27]
    v_mfma_f32_16x16x32_bf16 v[40:43], v[88:91], v[100:103], v[40:43]
    v_mfma_f32_16x16x32_bf16 v[56:59], v[88:91], v[104:107], v[56:59]
    v_mfma_f32_16x16x32_bf16 v[64:67], v[80:83], v[108:111], v[64:67]
    v_mfma_f32_16x16x32_bf16 v[68:71], v[84:87], v[108:111], v[68:71]
    v_mfma_f32_16x16x32_bf16 v[72:75], v[88:91], v[108:111], v[72:75]
    v_mfma_f32_16x16x32_bf16 v[28:31], v[92:95], v[96:99], v[28:31]
    v_mfma_f32_16x16x32_bf16 v[44:47], v[92:95], v[100:103], v[44:47]
    v_mfma_f32_16x16x32_bf16 v[60:63], v[92:95], v[104:107], v[60:63]
    v_mfma_f32_16x16x32_bf16 v[76:79], v[92:95], v[108:111], v[76:79]
    s_waitcnt lgkmcnt(0)
    v_mfma_f32_16x16x32_bf16 v[16:19], v[144:147], v[160:163], v[16:19]
    v_mfma_f32_16x16x32_bf16 v[32:35], v[144:147], v[164:167], v[32:35]
    s_waitcnt lgkmcnt(0)
    s_barrier
    ds_read_b64_tr_b16 v[80:81], v136 offset:32768
    ds_read_b64_tr_b16 v[82:83], v136 offset:33792
    v_mfma_f32_16x16x32_bf16 v[20:23], v[148:151], v[160:163], v[20:23]
    ds_read_b128 v[96:99], v130 offset:32768
    ds_read_b64_tr_b16 v[84:85], v137 offset:32768
    v_mfma_f32_16x16x32_bf16 v[36:39], v[148:151], v[164:167], v[36:39]
    ds_read_b64_tr_b16 v[86:87], v137 offset:33792
    ds_read_b128 v[100:103], v130 offset:36864
    v_mfma_f32_16x16x32_bf16 v[48:51], v[144:147], v[168:171], v[48:51]
    ds_read_b64_tr_b16 v[88:89], v138 offset:32768
    ds_read_b64_tr_b16 v[90:91], v138 offset:33792
    v_mfma_f32_16x16x32_bf16 v[52:55], v[148:151], v[168:171], v[52:55]
    ds_read_b128 v[104:107], v130 offset:40960
    ds_read_b64_tr_b16 v[92:93], v139 offset:32768
    v_mfma_f32_16x16x32_bf16 v[24:27], v[152:155], v[160:163], v[24:27]
    ds_read_b64_tr_b16 v[94:95], v139 offset:33792
    ds_read_b128 v[108:111], v130 offset:45056
    v_mfma_f32_16x16x32_bf16 v[40:43], v[152:155], v[164:167], v[40:43]
    v_mfma_f32_16x16x32_bf16 v[56:59], v[152:155], v[168:171], v[56:59]
    v_mfma_f32_16x16x32_bf16 v[64:67], v[144:147], v[172:175], v[64:67]
    v_mfma_f32_16x16x32_bf16 v[68:71], v[148:151], v[172:175], v[68:71]
    v_mfma_f32_16x16x32_bf16 v[72:75], v[152:155], v[172:175], v[72:75]
    v_mfma_f32_16x16x32_bf16 v[28:31], v[156:159], v[160:163], v[28:31]
    v_mfma_f32_16x16x32_bf16 v[44:47], v[156:159], v[164:167], v[44:47]
    v_mfma_f32_16x16x32_bf16 v[60:63], v[156:159], v[168:171], v[60:63]
    v_mfma_f32_16x16x32_bf16 v[76:79], v[156:159], v[172:175], v[76:79]
    s_waitcnt lgkmcnt(0)
    v_mfma_f32_16x16x32_bf16 v[16:19], v[80:83], v[96:99], v[16:19]
    ds_read_b64_tr_b16 v[144:145], v136 offset:49152
    ds_read_b64_tr_b16 v[146:147], v136 offset:50176
    v_mfma_f32_16x16x32_bf16 v[32:35], v[80:83], v[100:103], v[32:35]
    ds_read_b128 v[160:163], v131 offset:32768
    ds_read_b64_tr_b16 v[148:149], v137 offset:49152
    v_mfma_f32_16x16x32_bf16 v[20:23], v[84:87], v[96:99], v[20:23]
    ds_read_b64_tr_b16 v[150:151], v137 offset:50176
    ds_read_b128 v[164:167], v131 offset:36864
    v_mfma_f32_16x16x32_bf16 v[36:39], v[84:87], v[100:103], v[36:39]
    ds_read_b64_tr_b16 v[152:153], v138 offset:49152
    ds_read_b64_tr_b16 v[154:155], v138 offset:50176
    v_mfma_f32_16x16x32_bf16 v[48:51], v[80:83], v[104:107], v[48:51]
    ds_read_b128 v[168:171], v131 offset:40960
    ds_read_b64_tr_b16 v[156:157], v139 offset:49152
    v_mfma_f32_16x16x32_bf16 v[52:55], v[84:87], v[104:107], v[52:55]
    ds_read_b64_tr_b16 v[158:159], v139 offset:50176
    ds_read_b128 v[172:175], v131 offset:45056
    ds_read_b128 v[208:211], v11 offset:16
    v_mfma_f32_16x16x32_bf16 v[24:27], v[88:91], v[96:99], v[24:27]
    global_load_dwordx2 v[176:177], v140, s[30:31] offset:0 sc1
    v_mfma_f32_16x16x32_bf16 v[40:43], v[88:91], v[100:103], v[40:43]
    global_load_dwordx2 v[178:179], v140, s[30:31] offset:128 sc1
    v_mfma_f32_16x16x32_bf16 v[56:59], v[88:91], v[104:107], v[56:59]
    global_load_dwordx2 v[180:181], v140, s[30:31] offset:256 sc1
    v_mfma_f32_16x16x32_bf16 v[64:67], v[80:83], v[108:111], v[64:67]
    global_load_dwordx2 v[182:183], v140, s[30:31] offset:384 sc1
    v_mfma_f32_16x16x32_bf16 v[68:71], v[84:87], v[108:111], v[68:71]
    global_load_dwordx4 v[184:187], v143, s[30:31] sc1
    v_mfma_f32_16x16x32_bf16 v[72:75], v[88:91], v[108:111], v[72:75]
    global_load_dwordx4 v[188:191], v143, s[30:31] offset:16 sc1
    v_mfma_f32_16x16x32_bf16 v[28:31], v[92:95], v[96:99], v[28:31]
    v_mov_b32 v10, 6
    ds_write_b32 v8, v10
    v_mfma_f32_16x16x32_bf16 v[44:47], v[92:95], v[100:103], v[44:47]
    v_mfma_f32_16x16x32_bf16 v[60:63], v[92:95], v[104:107], v[60:63]
    v_mfma_f32_16x16x32_bf16 v[76:79], v[92:95], v[108:111], v[76:79]
    s_waitcnt lgkmcnt(2)
    v_mfma_f32_16x16x32_bf16 v[16:19], v[144:147], v[160:163], v[16:19]
    v_mfma_f32_16x16x32_bf16 v[32:35], v[144:147], v[164:167], v[32:35]
    s_waitcnt lgkmcnt(1)
    v_min_u32 v208, v208, v209
    v_min3_u32 v208, v208, v210, v211
    v_cmp_gt_u32 vcc, 6, v208
    s_nop 4
    s_cbranch_vccnz Lretry1
Ldone1:
    ds_read_b64_tr_b16 v[80:81], v132 offset:0
    ds_read_b64_tr_b16 v[82:83], v132 offset:1024
    v_mfma_f32_16x16x32_bf16 v[20:23], v[148:151], v[160:163], v[20:23]
    ds_read_b128 v[96:99], v128 offset:0
    ds_read_b64_tr_b16 v[84:85], v133 offset:0
    v_mfma_f32_16x16x32_bf16 v[36:39], v[148:151], v[164:167], v[36:39]
    ds_read_b64_tr_b16 v[86:87], v133 offset:1024
    ds_read_b128 v[100:103], v128 offset:4096
    v_mfma_f32_16x16x32_bf16 v[48:51], v[144:147], v[168:171], v[48:51]
    ds_read_b64_tr_b16 v[88:89], v134 offset:0
    ds_read_b64_tr_b16 v[90:91], v134 offset:1024
    v_mfma_f32_16x16x32_bf16 v[52:55], v[148:151], v[168:171], v[52:55]
    ds_read_b128 v[104:107], v128 offset:8192
    ds_read_b64_tr_b16 v[92:93], v135 offset:0
    v_mfma_f32_16x16x32_bf16 v[24:27], v[152:155], v[160:163], v[24:27]
    ds_read_b64_tr_b16 v[94:95], v135 offset:1024
    ds_read_b128 v[108:111], v128 offset:12288
    v_mfma_f32_16x16x32_bf16 v[40:43], v[152:155], v[164:167], v[40:43]
    v_mfma_f32_16x16x32_bf16 v[56:59], v[152:155], v[168:171], v[56:59]
    v_mfma_f32_16x16x32_bf16 v[64:67], v[144:147], v[172:175], v[64:67]
    v_mfma_f32_16x16x32_bf16 v[68:71], v[148:151], v[172:175], v[68:71]
    v_mfma_f32_16x16x32_bf16 v[72:75], v[152:155], v[172:175], v[72:75]
    v_mfma_f32_16x16x32_bf16 v[28:31], v[156:159], v[160:163], v[28:31]
    v_mfma_f32_16x16x32_bf16 v[44:47], v[156:159], v[164:167], v[44:47]
    v_mfma_f32_16x16x32_bf16 v[60:63], v[156:159], v[168:171], v[60:63]
    v_mfma_f32_16x16x32_bf16 v[76:79], v[156:159], v[172:175], v[76:79]
    s_waitcnt lgkmcnt(0)
    v_mfma_f32_16x16x32_bf16 v[16:19], v[80:83], v[96:99], v[16:19]
    ds_read_b64_tr_b16 v[144:145], v132 offset:16384
    ds_read_b64_tr_b16 v[146:147], v132 offset:17408
    v_mfma_f32_16x16x32_bf16 v[32:35], v[80:83], v[100:103], v[32:35]
    ds_read_b128 v[160:163], v129 offset:0
    ds_read_b64_tr_b16 v[148:149], v133 offset:16384
    v_mfma_f32_16x16x32_bf16 v[20:23], v[84:87], v[96:99], v[20:23]
    ds_read_b64_tr_b16 v[150:151], v133 offset:17408
    ds_read_b128 v[164:167], v129 offset:4096
    v_mfma_f32_16x16x32_bf16 v[36:39], v[84:87], v[100:103], v[36:39]
    ds_read_b64_tr_b16 v[152:153], v134 offset:16384
    ds_read_b64_tr_b16 v[154:155], v134 offset:17408
    v_mfma_f32_16x16x32_bf16 v[48:51], v[80:83], v[104:107], v[48:51]
    ds_read_b128 v[168:171], v129 offset:8192
    ds_read_b64_tr_b16 v[156:157], v135 offset:16384
    v_mfma_f32_16x16x32_bf16 v[52:55], v[84:87], v[104:107], v[52:55]
    ds_read_b64_tr_b16 v[158:159], v135 offset:17408
    ds_read_b128 v[172:175], v129 offset:12288
    ds_read_b128 v[208:211], v11 offset:16
    v_mfma_f32_16x16x32_bf16 v[24:27], v[88:91], v[96:99], v[24:27]
    v_mfma_f32_16x16x32_bf16 v[40:43], v[88:91], v[100:103], v[40:43]
    v_mfma_f32_16x16x32_bf16 v[56:59], v[88:91], v[104:107], v[56:59]
    v_mfma_f32_16x16x32_bf16 v[64:67], v[80:83], v[108:111], v[64:67]
    v_mfma_f32_16x16x32_bf16 v[68:71], v[84:87], v[108:111], v[68:71]
    v_mfma_f32_16x16x32_bf16 v[72:75], v[88:91], v[108:111], v[72:75]
    v_mfma_f32_16x16x32_bf16 v[28:31], v[92:95], v[96:99], v[28:31]
    v_mfma_f32_16x16x32_bf16 v[44:47], v[92:95], v[100:103], v[44:47]
    v_mfma_f32_16x16x32_bf16 v[60:63], v[92:95], v[104:107], v[60:63]
    v_mfma_f32_16x16x32_bf16 v[76:79], v[92:95], v[108:111], v[76:79]
    s_waitcnt lgkmcnt(1)
    v_mfma_f32_16x16x32_bf16 v[16:19], v[144:147], v[160:163], v[16:19]
    v_mfma_f32_16x16x32_bf16 v[32:35], v[144:147], v[164:167], v[32:35]
    s_waitcnt lgkmcnt(0)
    v_min_u32 v208, v208, v209
    v_min3_u32 v208, v208, v210, v211
    v_cmp_gt_u32 vcc, 7, v208
    s_nop 4
    s_cbranch_vccnz Lretry2
Ldone2:
    ds_read_b64_tr_b16 v[80:81], v132 offset:32768
    ds_read_b64_tr_b16 v[82:83], v132 offset:33792
    v_mfma_f32_16x16x32_bf16 v[20:23], v[148:151], v[160:163], v[20:23]
    ds_read_b128 v[96:99], v128 offset:32768
    ds_read_b64_tr_b16 v[84:85], v133 offset:32768
    v_mfma_f32_16x16x32_bf16 v[36:39], v[148:151], v[164:167], v[36:39]
    ds_read_b64_tr_b16 v[86:87], v133 offset:33792
    ds_read_b128 v[100:103], v128 offset:36864
    v_mfma_f32_16x16x32_bf16 v[48:51], v[144:147], v[168:171], v[48:51]
    ds_read_b64_tr_b16 v[88:89], v134 offset:32768
    ds_read_b64_tr_b16 v[90:91], v134 offset:33792
    v_mfma_f32_16x16x32_bf16 v[52:55], v[148:151], v[168:171], v[52:55]
    ds_read_b128 v[104:107], v128 offset:40960
    ds_read_b64_tr_b16 v[92:93], v135 offset:32768
    v_mfma_f32_16x16x32_bf16 v[24:27], v[152:155], v[160:163], v[24:27]
    ds_read_b64_tr_b16 v[94:95], v135 offset:33792
    ds_read_b128 v[108:111], v128 offset:45056
    v_mfma_f32_16x16x32_bf16 v[40:43], v[152:155], v[164:167], v[40:43]
    v_mfma_f32_16x16x32_bf16 v[56:59], v[152:155], v[168:171], v[56:59]
    v_mfma_f32_16x16x32_bf16 v[64:67], v[144:147], v[172:175], v[64:67]
    v_mfma_f32_16x16x32_bf16 v[68:71], v[148:151], v[172:175], v[68:71]
    v_mfma_f32_16x16x32_bf16 v[72:75], v[152:155], v[172:175], v[72:75]
    v_mfma_f32_16x16x32_bf16 v[28:31], v[156:159], v[160:163], v[28:31]
    v_mfma_f32_16x16x32_bf16 v[44:47], v[156:159], v[164:167], v[44:47]
    v_mfma_f32_16x16x32_bf16 v[60:63], v[156:159], v[168:171], v[60:63]
    v_mfma_f32_16x16x32_bf16 v[76:79], v[156:159], v[172:175], v[76:79]
    s_waitcnt lgkmcnt(0)
    v_mfma_f32_16x16x32_bf16 v[16:19], v[80:83], v[96:99], v[16:19]
    ds_read_b64_tr_b16 v[144:145], v132 offset:49152
    ds_read_b64_tr_b16 v[146:147], v132 offset:50176
    v_mfma_f32_16x16x32_bf16 v[32:35], v[80:83], v[100:103], v[32:35]
    ds_read_b128 v[160:163], v129 offset:32768
    ds_read_b64_tr_b16 v[148:149], v133 offset:49152
    v_mfma_f32_16x16x32_bf16 v[20:23], v[84:87], v[96:99], v[20:23]
    ds_read_b64_tr_b16 v[150:151], v133 offset:50176
    ds_read_b128 v[164:167], v129 offset:36864
    v_mfma_f32_16x16x32_bf16 v[36:39], v[84:87], v[100:103], v[36:39]
    ds_read_b64_tr_b16 v[152:153], v134 offset:49152
    ds_read_b64_tr_b16 v[154:155], v134 offset:50176
    v_mfma_f32_16x16x32_bf16 v[48:51], v[80:83], v[104:107], v[48:51]
    ds_read_b128 v[168:171], v129 offset:40960
    ds_read_b64_tr_b16 v[156:157], v135 offset:49152
    v_mfma_f32_16x16x32_bf16 v[52:55], v[84:87], v[104:107], v[52:55]
    ds_read_b64_tr_b16 v[158:159], v135 offset:50176
    ds_read_b128 v[172:175], v129 offset:45056
    ds_read_b128 v[208:211], v11 offset:16
    v_mfma_f32_16x16x32_bf16 v[24:27], v[88:91], v[96:99], v[24:27]
    v_mfma_f32_16x16x32_bf16 v[40:43], v[88:91], v[100:103], v[40:43]
    v_mfma_f32_16x16x32_bf16 v[56:59], v[88:91], v[104:107], v[56:59]
    v_mfma_f32_16x16x32_bf16 v[64:67], v[80:83], v[108:111], v[64:67]
    v_mfma_f32_16x16x32_bf16 v[68:71], v[84:87], v[108:111], v[68:71]
    v_mfma_f32_16x16x32_bf16 v[72:75], v[88:91], v[108:111], v[72:75]
    v_mfma_f32_16x16x32_bf16 v[28:31], v[92:95], v[96:99], v[28:31]
    v_mfma_f32_16x16x32_bf16 v[44:47], v[92:95], v[100:103], v[44:47]
    v_mfma_f32_16x16x32_bf16 v[60:63], v[92:95], v[104:107], v[60:63]
    v_mfma_f32_16x16x32_bf16 v[76:79], v[92:95], v[108:111], v[76:79]
    s_waitcnt lgkmcnt(1)
    v_mfma_f32_16x16x32_bf16 v[16:19], v[144:147], v[160:163], v[16:19]
    v_mfma_f32_16x16x32_bf16 v[32:35], v[144:147], v[164:167], v[32:35]
    s_waitcnt lgkmcnt(0)
    v_min_u32 v208, v208, v209
    v_min3_u32 v208, v208, v210, v211
    v_cmp_gt_u32 vcc, 8, v208
    s_nop 4
    s_cbranch_vccnz Lretry3
Ldone3:
    ds_read_b64_tr_b16 v[80:81], v136 offset:0
    ds_read_b64_tr_b16 v[82:83], v136 offset:1024
    v_mfma_f32_16x16x32_bf16 v[20:23], v[148:151], v[160:163], v[20:23]
    ds_read_b128 v[96:99], v130 offset:0
    ds_read_b64_tr_b16 v[84:85], v137 offset:0
    v_mfma_f32_16x16x32_bf16 v[36:39], v[148:151], v[164:167], v[36:39]
    ds_read_b64_tr_b16 v[86:87], v137 offset:1024
    ds_read_b128 v[100:103], v130 offset:4096
    v_mfma_f32_16x16x32_bf16 v[48:51], v[144:147], v[168:171], v[48:51]
    ds_read_b64_tr_b16 v[88:89], v138 offset:0
    ds_read_b64_tr_b16 v[90:91], v138 offset:1024
    v_mfma_f32_16x16x32_bf16 v[52:55], v[148:151], v[168:171], v[52:55]
    ds_read_b128 v[104:107], v130 offset:8192
    ds_read_b64_tr_b16 v[92:93], v139 offset:0
    v_mfma_f32_16x16x32_bf16 v[24:27], v[152:155], v[160:163], v[24:27]
    ds_read_b64_tr_b16 v[94:95], v139 offset:1024
    ds_read_b128 v[108:111], v130 offset:12288
    v_mfma_f32_16x16x32_bf16 v[40:43], v[152:155], v[164:167], v[40:43]
    v_mfma_f32_16x16x32_bf16 v[56:59], v[152:155], v[168:171], v[56:59]
    v_mfma_f32_16x16x32_bf16 v[64:67], v[144:147], v[172:175], v[64:67]
    v_mfma_f32_16x16x32_bf16 v[68:71], v[148:151], v[172:175], v[68:71]
    v_mfma_f32_16x16x32_bf16 v[72:75], v[152:155], v[172:175], v[72:75]
    v_mfma_f32_16x16x32_bf16 v[28:31], v[156:159], v[160:163], v[28:31]
    v_mfma_f32_16x16x32_bf16 v[44:47], v[156:159], v[164:167], v[44:47]
    v_mfma_f32_16x16x32_bf16 v[60:63], v[156:159], v[168:171], v[60:63]
    v_mfma_f32_16x16x32_bf16 v[76:79], v[156:159], v[172:175], v[76:79]
    s_waitcnt lgkmcnt(0)
    v_mfma_f32_16x16x32_bf16 v[16:19], v[80:83], v[96:99], v[16:19]
    ds_read_b64_tr_b16 v[144:145], v136 offset:16384
    ds_read_b64_tr_b16 v[146:147], v136 offset:17408
    v_mfma_f32_16x16x32_bf16 v[32:35], v[80:83], v[100:103], v[32:35]
    ds_read_b128 v[160:163], v131 offset:0
    ds_read_b64_tr_b16 v[148:149], v137 offset:16384
    v_mfma_f32_16x16x32_bf16 v[20:23], v[84:87], v[96:99], v[20:23]
    ds_read_b64_tr_b16 v[150:151], v137 offset:17408
    ds_read_b128 v[164:167], v131 offset:4096
    v_mfma_f32_16x16x32_bf16 v[36:39], v[84:87], v[100:103], v[36:39]
    ds_read_b64_tr_b16 v[152:153], v138 offset:16384
    ds_read_b64_tr_b16 v[154:155], v138 offset:17408
    v_mfma_f32_16x16x32_bf16 v[48:51], v[80:83], v[104:107], v[48:51]
    ds_read_b128 v[168:171], v131 offset:8192
    ds_read_b64_tr_b16 v[156:157], v139 offset:16384
    v_mfma_f32_16x16x32_bf16 v[52:55], v[84:87], v[104:107], v[52:55]
    ds_read_b64_tr_b16 v[158:159], v139 offset:17408
    ds_read_b128 v[172:175], v131 offset:12288
    v_mov_b32 v10, 7
    ds_write_b32 v8, v10
    s_waitcnt vmcnt(0)
    v_min_u32 v192, v177, v179
    v_max_u32 v193, v177, v179
    v_min3_u32 v192, v192, v181, v183
    v_max3_u32 v193, v193, v181, v183
    v_min3_u32 v192, v192, v185, v187
    v_max3_u32 v193, v193, v185, v187
    v_min3_u32 v192, v192, v189, v191
    v_max3_u32 v193, v193, v189, v191
    v_xor_b32 v192, s3, v192
    v_xor_b32 v193, s3, v193
    v_or_b32 v192, v192, v193
    v_cmp_ne_u32 vcc, 0, v192
    s_nop 4
    s_cbranch_vccnz Lretry4
Ldone4:
    v_mfma_f32_16x16x32_bf16 v[24:27], v[88:91], v[96:99], v[24:27]
    v_add_f32 v184, v184, v186
    v_add_f32 v188, v188, v190
    v_mfma_f32_16x16x32_bf16 v[40:43], v[88:91], v[100:103], v[40:43]
    v_add_f32 v184, v184, v188
    v_cvt_pk_bf16_f32 v185, v184, v184
    v_mfma_f32_16x16x32_bf16 v[56:59], v[88:91], v[104:107], v[56:59]
    v_lshlrev_b32 v185, 16, v185
    v_sub_f32 v185, v184, v185
    v_mfma_f32_16x16x32_bf16 v[64:67], v[80:83], v[108:111], v[64:67]
    v_cvt_pk_bf16_f32 v184, v184, v185
    v_cndmask_b32 v216, 0, v184, s[6:7]
    v_mfma_f32_16x16x32_bf16 v[68:71], v[84:87], v[108:111], v[68:71]
    v_cndmask_b32 v217, 0, v142, s[6:7]
    v_cndmask_b32 v220, 0, v184, s[8:9]
    v_mfma_f32_16x16x32_bf16 v[72:75], v[88:91], v[108:111], v[72:75]
    v_cndmask_b32 v221, 0, v142, s[8:9]
    v_cndmask_b32 v224, 0, v184, s[10:11]
    v_mfma_f32_16x16x32_bf16 v[28:31], v[92:95], v[96:99], v[28:31]
    v_cndmask_b32 v225, 0, v142, s[10:11]
    v_cndmask_b32 v228, 0, v184, s[12:13]
    v_mfma_f32_16x16x32_bf16 v[44:47], v[92:95], v[100:103], v[44:47]
    v_cndmask_b32 v229, 0, v142, s[12:13]
    v_and_b32 v248, 0xffff0000, v176
    v_mfma_f32_16x16x32_bf16 v[60:63], v[92:95], v[104:107], v[60:63]
    v_and_b32 v232, 0xffff, v176
    v_rcp_f32 v248, v248
    v_mfma_f32_16x16x32_bf16 v[76:79], v[92:95], v[108:111], v[76:79]
    v_lshrrev_b32 v233, 16, v176
    v_lshl_or_b32 v232, v232, 16, v232
    s_waitcnt lgkmcnt(1)
    v_mfma_f32_16x16x32_bf16 v[16:19], v[144:147], v[160:163], v[16:19]
    v_mfma_f32_16x16x32_bf16 v[32:35], v[144:147], v[164:167], v[32:35]
    v_xor_b32 v232, 0x80008000, v232
    v_mul_f32 v248, 0x3fb8aa3b, v248
    v_mfma_f32_16x16x32_bf16 v[20:23], v[148:151], v[160:163], v[20:23]
    v_and_b32 v250, 0xffff0000, v178
    v_and_b32 v236, 0xffff, v178
    v_mfma_f32_16x16x32_bf16 v[36:39], v[148:151], v[164:167], v[36:39]
    v_rcp_f32 v250, v250
    v_mfma_f32_16x16x32_bf16 v[48:51], v[144:147], v[168:171], v[48:51]
    v_lshrrev_b32 v237, 16, v178
    v_lshl_or_b32 v236, v236, 16, v236
    v_mfma_f32_16x16x32_bf16 v[52:55], v[148:151], v[168:171], v[52:55]
    v_xor_b32 v236, 0x80008000, v236
    v_mul_f32 v250, 0x3fb8aa3b, v250
    v_mfma_f32_16x16x32_bf16 v[24:27], v[152:155], v[160:163], v[24:27]
    v_and_b32 v252, 0xffff0000, v180
    v_and_b32 v240, 0xffff, v180
    v_mfma_f32_16x16x32_bf16 v[40:43], v[152:155], v[164:167], v[40:43]
    v_rcp_f32 v252, v252
    v_mfma_f32_16x16x32_bf16 v[56:59], v[152:155], v[168:171], v[56:59]
    v_lshrrev_b32 v241, 16, v180
    v_lshl_or_b32 v240, v240, 16, v240
    v_mfma_f32_16x16x32_bf16 v[64:67], v[144:147], v[172:175], v[64:67]
    v_xor_b32 v240, 0x80008000, v240
    v_mul_f32 v252, 0x3fb8aa3b, v252
    v_mfma_f32_16x16x32_bf16 v[68:71], v[148:151], v[172:175], v[68:71]
    v_and_b32 v254, 0xffff0000, v182
    v_and_b32 v244, 0xffff, v182
    v_mfma_f32_16x16x32_bf16 v[72:75], v[152:155], v[172:175], v[72:75]
    v_rcp_f32 v254, v254
    v_mfma_f32_16x16x32_bf16 v[28:31], v[156:159], v[160:163], v[28:31]
    v_lshrrev_b32 v245, 16, v182
    v_lshl_or_b32 v244, v244, 16, v244
    v_mfma_f32_16x16x32_bf16 v[44:47], v[156:159], v[164:167], v[44:47]
    v_xor_b32 v244, 0x80008000, v244
    v_mul_f32 v254, 0x3fb8aa3b, v254
    v_mfma_f32_16x16x32_bf16 v[60:63], v[156:159], v[168:171], v[60:63]
    v_mfma_f32_16x16x32_bf16 v[76:79], v[156:159], v[172:175], v[76:79]
    v_mfma_f32_16x16x32_bf16 v[16:19], v[216:219], v[232:235], v[16:19]
    v_mfma_f32_16x16x32_bf16 v[20:23], v[220:223], v[232:235], v[20:23]
    v_mfma_f32_16x16x32_bf16 v[24:27], v[224:227], v[232:235], v[24:27]
    v_mfma_f32_16x16x32_bf16 v[28:31], v[228:231], v[232:235], v[28:31]
    v_mfma_f32_16x16x32_bf16 v[32:35], v[216:219], v[236:239], v[32:35]
    v_mfma_f32_16x16x32_bf16 v[36:39], v[220:223], v[236:239], v[36:39]
    v_mfma_f32_16x16x32_bf16 v[40:43], v[224:227], v[236:239], v[40:43]
    v_mfma_f32_16x16x32_bf16 v[44:47], v[228:231], v[236:239], v[44:47]
    v_mfma_f32_16x16x32_bf16 v[48:51], v[216:219], v[240:243], v[48:51]
    v_mfma_f32_16x16x32_bf16 v[52:55], v[220:223], v[240:243], v[52:55]
    v_mfma_f32_16x16x32_bf16 v[56:59], v[224:227], v[240:243], v[56:59]
    v_mfma_f32_16x16x32_bf16 v[60:63], v[228:231], v[240:243], v[60:63]
    v_mfma_f32_16x16x32_bf16 v[64:67], v[216:219], v[244:247], v[64:67]
    v_mfma_f32_16x16x32_bf16 v[68:71], v[220:223], v[244:247], v[68:71]
    v_mfma_f32_16x16x32_bf16 v[72:75], v[224:227], v[244:247], v[72:75]
    v_mfma_f32_16x16x32_bf16 v[76:79], v[228:231], v[244:247], v[76:79]
    v_pk_mul_f32 v[16:17], v[16:17], v[248:249] op_sel_hi:[1,0]
    v_pk_mul_f32 v[18:19], v[18:19], v[248:249] op_sel_hi:[1,0]
    v_pk_mul_f32 v[20:21], v[20:21], v[248:249] op_sel_hi:[1,0]
    v_pk_mul_f32 v[22:23], v[22:23], v[248:249] op_sel_hi:[1,0]
    v_exp_f32 v96, v16
    v_exp_f32 v97, v17
    v_exp_f32 v98, v18
    v_exp_f32 v99, v19
    v_exp_f32 v100, v20
    v_exp_f32 v101, v21
    v_exp_f32 v102, v22
    v_exp_f32 v103, v23
    v_pk_fma_f32 v[104:105], v[96:97], -0.5, -1.0 op_sel_hi:[1,0,0]
    v_pk_fma_f32 v[106:107], v[98:99], -0.5, -1.0 op_sel_hi:[1,0,0]
    v_pk_fma_f32 v[108:109], v[100:101], -0.5, -1.0 op_sel_hi:[1,0,0]
    v_pk_fma_f32 v[110:111], v[102:103], -0.5, -1.0 op_sel_hi:[1,0,0]
    v_pk_fma_f32 v[96:97], v[96:97], v[104:105], -1.0 op_sel_hi:[1,1,0]
    v_pk_fma_f32 v[98:99], v[98:99], v[106:107], -1.0 op_sel_hi:[1,1,0]
    v_pk_fma_f32 v[100:101], v[100:101], v[108:109], -1.0 op_sel_hi:[1,1,0]
    v_pk_fma_f32 v[102:103], v[102:103], v[110:111], -1.0 op_sel_hi:[1,1,0]
    v_rcp_f32 v96, v96
    v_rcp_f32 v97, v97
    v_rcp_f32 v98, v98
    v_rcp_f32 v99, v99
    v_rcp_f32 v100, v100
    v_rcp_f32 v101, v101
    v_rcp_f32 v102, v102
    v_rcp_f32 v103, v103
    v_pk_fma_f32 v[96:97], v[16:17], v[96:97], v[16:17]
    v_pk_fma_f32 v[98:99], v[18:19], v[98:99], v[18:19]
    v_pk_fma_f32 v[100:101], v[20:21], v[100:101], v[20:21]
    v_pk_fma_f32 v[102:103], v[22:23], v[102:103], v[22:23]
    v_cvt_pk_bf16_f32 v16, v96, v97
    v_cvt_pk_bf16_f32 v17, v98, v99
    v_cvt_pk_bf16_f32 v18, v100, v101
    v_cvt_pk_bf16_f32 v19, v102, v103
    buffer_store_dwordx4 v[16:19], v3, s[44:47], s32 offen offset:0 sc1
    v_pk_mul_f32 v[24:25], v[24:25], v[248:249] op_sel_hi:[1,0]
    v_pk_mul_f32 v[26:27], v[26:27], v[248:249] op_sel_hi:[1,0]
    v_pk_mul_f32 v[28:29], v[28:29], v[248:249] op_sel_hi:[1,0]
    v_pk_mul_f32 v[30:31], v[30:31], v[248:249] op_sel_hi:[1,0]
    v_exp_f32 v112, v24
    v_exp_f32 v113, v25
    v_exp_f32 v114, v26
    v_exp_f32 v115, v27
    v_exp_f32 v116, v28
    v_exp_f32 v117, v29
    v_exp_f32 v118, v30
    v_exp_f32 v119, v31
    v_pk_fma_f32 v[120:121], v[112:113], -0.5, -1.0 op_sel_hi:[1,0,0]
    v_pk_fma_f32 v[122:123], v[114:115], -0.5, -1.0 op_sel_hi:[1,0,0]
    v_pk_fma_f32 v[124:125], v[116:117], -0.5, -1.0 op_sel_hi:[1,0,0]
    v_pk_fma_f32 v[126:127], v[118:119], -0.5, -1.0 op_sel_hi:[1,0,0]
    v_pk_fma_f32 v[112:113], v[112:113], v[120:121], -1.0 op_sel_hi:[1,1,0]
    v_pk_fma_f32 v[114:115], v[114:115], v[122:123], -1.0 op_sel_hi:[1,1,0]
    v_pk_fma_f32 v[116:117], v[116:117], v[124:125], -1.0 op_sel_hi:[1,1,0]
    v_pk_fma_f32 v[118:119], v[118:119], v[126:127], -1.0 op_sel_hi:[1,1,0]
    v_rcp_f32 v112, v112
    v_rcp_f32 v113, v113
    v_rcp_f32 v114, v114
    v_rcp_f32 v115, v115
    v_rcp_f32 v116, v116
    v_rcp_f32 v117, v117
    v_rcp_f32 v118, v118
    v_rcp_f32 v119, v119
    v_pk_fma_f32 v[112:113], v[24:25], v[112:113], v[24:25]
    v_pk_fma_f32 v[114:115], v[26:27], v[114:115], v[26:27]
    v_pk_fma_f32 v[116:117], v[28:29], v[116:117], v[28:29]
    v_pk_fma_f32 v[118:119], v[30:31], v[118:119], v[30:31]
    v_cvt_pk_bf16_f32 v24, v112, v113
    v_cvt_pk_bf16_f32 v25, v114, v115
    v_cvt_pk_bf16_f32 v26, v116, v117
    v_cvt_pk_bf16_f32 v27, v118, v119
    buffer_store_dwordx4 v[24:27], v3, s[44:47], s32 offen offset:1024 sc1
    s_add_u32 s32, s32, 57344
    v_pk_mul_f32 v[32:33], v[32:33], v[250:251] op_sel_hi:[1,0]
    v_pk_mul_f32 v[34:35], v[34:35], v[250:251] op_sel_hi:[1,0]
    v_pk_mul_f32 v[36:37], v[36:37], v[250:251] op_sel_hi:[1,0]
    v_pk_mul_f32 v[38:39], v[38:39], v[250:251] op_sel_hi:[1,0]
    v_exp_f32 v96, v32
    v_exp_f32 v97, v33
    v_exp_f32 v98, v34
    v_exp_f32 v99, v35
    v_exp_f32 v100, v36
    v_exp_f32 v101, v37
    v_exp_f32 v102, v38
    v_exp_f32 v103, v39
    v_pk_fma_f32 v[104:105], v[96:97], -0.5, -1.0 op_sel_hi:[1,0,0]
    v_pk_fma_f32 v[106:107], v[98:99], -0.5, -1.0 op_sel_hi:[1,0,0]
    v_pk_fma_f32 v[108:109], v[100:101], -0.5, -1.0 op_sel_hi:[1,0,0]
    v_pk_fma_f32 v[110:111], v[102:103], -0.5, -1.0 op_sel_hi:[1,0,0]
    v_pk_fma_f32 v[96:97], v[96:97], v[104:105], -1.0 op_sel_hi:[1,1,0]
    v_pk_fma_f32 v[98:99], v[98:99], v[106:107], -1.0 op_sel_hi:[1,1,0]
    v_pk_fma_f32 v[100:101], v[100:101], v[108:109], -1.0 op_sel_hi:[1,1,0]
    v_pk_fma_f32 v[102:103], v[102:103], v[110:111], -1.0 op_sel_hi:[1,1,0]
    v_rcp_f32 v96, v96
    v_rcp_f32 v97, v97
    v_rcp_f32 v98, v98
    v_rcp_f32 v99, v99
    v_rcp_f32 v100, v100
    v_rcp_f32 v101, v101
    v_rcp_f32 v102, v102
    v_rcp_f32 v103, v103
    v_pk_fma_f32 v[96:97], v[32:33], v[96:97], v[32:33]
    v_pk_fma_f32 v[98:99], v[34:35], v[98:99], v[34:35]
    v_pk_fma_f32 v[100:101], v[36:37], v[100:101], v[36:37]
    v_pk_fma_f32 v[102:103], v[38:39], v[102:103], v[38:39]
    v_cvt_pk_bf16_f32 v32, v96, v97
    v_cvt_pk_bf16_f32 v33, v98, v99
    v_cvt_pk_bf16_f32 v34, v100, v101
    v_cvt_pk_bf16_f32 v35, v102, v103
    buffer_store_dwordx4 v[32:35], v3, s[44:47], s32 offen offset:0 sc1
    v_pk_mul_f32 v[40:41], v[40:41], v[250:251] op_sel_hi:[1,0]
    v_pk_mul_f32 v[42:43], v[42:43], v[250:251] op_sel_hi:[1,0]
    v_pk_mul_f32 v[44:45], v[44:45], v[250:251] op_sel_hi:[1,0]
    v_pk_mul_f32 v[46:47], v[46:47], v[250:251] op_sel_hi:[1,0]
    v_exp_f32 v112, v40
    v_exp_f32 v113, v41
    v_exp_f32 v114, v42
    v_exp_f32 v115, v43
    v_exp_f32 v116, v44
    v_exp_f32 v117, v45
    v_exp_f32 v118, v46
    v_exp_f32 v119, v47
    v_pk_fma_f32 v[120:121], v[112:113], -0.5, -1.0 op_sel_hi:[1,0,0]
    v_pk_fma_f32 v[122:123], v[114:115], -0.5, -1.0 op_sel_hi:[1,0,0]
    v_pk_fma_f32 v[124:125], v[116:117], -0.5, -1.0 op_sel_hi:[1,0,0]
    v_pk_fma_f32 v[126:127], v[118:119], -0.5, -1.0 op_sel_hi:[1,0,0]
    v_pk_fma_f32 v[112:113], v[112:113], v[120:121], -1.0 op_sel_hi:[1,1,0]
    v_pk_fma_f32 v[114:115], v[114:115], v[122:123], -1.0 op_sel_hi:[1,1,0]
    v_pk_fma_f32 v[116:117], v[116:117], v[124:125], -1.0 op_sel_hi:[1,1,0]
    v_pk_fma_f32 v[118:119], v[118:119], v[126:127], -1.0 op_sel_hi:[1,1,0]
    v_rcp_f32 v112, v112
    v_rcp_f32 v113, v113
    v_rcp_f32 v114, v114
    v_rcp_f32 v115, v115
    v_rcp_f32 v116, v116
    v_rcp_f32 v117, v117
    v_rcp_f32 v118, v118
    v_rcp_f32 v119, v119
    v_pk_fma_f32 v[112:113], v[40:41], v[112:113], v[40:41]
    v_pk_fma_f32 v[114:115], v[42:43], v[114:115], v[42:43]
    v_pk_fma_f32 v[116:117], v[44:45], v[116:117], v[44:45]
    v_pk_fma_f32 v[118:119], v[46:47], v[118:119], v[46:47]
    v_cvt_pk_bf16_f32 v40, v112, v113
    v_cvt_pk_bf16_f32 v41, v114, v115
    v_cvt_pk_bf16_f32 v42, v116, v117
    v_cvt_pk_bf16_f32 v43, v118, v119
    buffer_store_dwordx4 v[40:43], v3, s[44:47], s32 offen offset:1024 sc1
    s_add_u32 s32, s32, 57344
    v_pk_mul_f32 v[48:49], v[48:49], v[252:253] op_sel_hi:[1,0]
    v_pk_mul_f32 v[50:51], v[50:51], v[252:253] op_sel_hi:[1,0]
    v_pk_mul_f32 v[52:53], v[52:53], v[252:253] op_sel_hi:[1,0]
    v_pk_mul_f32 v[54:55], v[54:55], v[252:253] op_sel_hi:[1,0]
    v_exp_f32 v96, v48
    v_exp_f32 v97, v49
    v_exp_f32 v98, v50
    v_exp_f32 v99, v51
    v_exp_f32 v100, v52
    v_exp_f32 v101, v53
    v_exp_f32 v102, v54
    v_exp_f32 v103, v55
    v_pk_fma_f32 v[104:105], v[96:97], -0.5, -1.0 op_sel_hi:[1,0,0]
    v_pk_fma_f32 v[106:107], v[98:99], -0.5, -1.0 op_sel_hi:[1,0,0]
    v_pk_fma_f32 v[108:109], v[100:101], -0.5, -1.0 op_sel_hi:[1,0,0]
    v_pk_fma_f32 v[110:111], v[102:103], -0.5, -1.0 op_sel_hi:[1,0,0]
    v_pk_fma_f32 v[96:97], v[96:97], v[104:105], -1.0 op_sel_hi:[1,1,0]
    v_pk_fma_f32 v[98:99], v[98:99], v[106:107], -1.0 op_sel_hi:[1,1,0]
    v_pk_fma_f32 v[100:101], v[100:101], v[108:109], -1.0 op_sel_hi:[1,1,0]
    v_pk_fma_f32 v[102:103], v[102:103], v[110:111], -1.0 op_sel_hi:[1,1,0]
    v_rcp_f32 v96, v96
    v_rcp_f32 v97, v97
    v_rcp_f32 v98, v98
    v_rcp_f32 v99, v99
    v_rcp_f32 v100, v100
    v_rcp_f32 v101, v101
    v_rcp_f32 v102, v102
    v_rcp_f32 v103, v103
    v_pk_fma_f32 v[96:97], v[48:49], v[96:97], v[48:49]
    v_pk_fma_f32 v[98:99], v[50:51], v[98:99], v[50:51]
    v_pk_fma_f32 v[100:101], v[52:53], v[100:101], v[52:53]
    v_pk_fma_f32 v[102:103], v[54:55], v[102:103], v[54:55]
    v_cvt_pk_bf16_f32 v48, v96, v97
    v_cvt_pk_bf16_f32 v49, v98, v99
    v_cvt_pk_bf16_f32 v50, v100, v101
    v_cvt_pk_bf16_f32 v51, v102, v103
    buffer_store_dwordx4 v[48:51], v3, s[44:47], s32 offen offset:0 sc1
    v_pk_mul_f32 v[56:57], v[56:57], v[252:253] op_sel_hi:[1,0]
    v_pk_mul_f32 v[58:59], v[58:59], v[252:253] op_sel_hi:[1,0]
    v_pk_mul_f32 v[60:61], v[60:61], v[252:253] op_sel_hi:[1,0]
    v_pk_mul_f32 v[62:63], v[62:63], v[252:253] op_sel_hi:[1,0]
    v_exp_f32 v112, v56
    v_exp_f32 v113, v57
    v_exp_f32 v114, v58
    v_exp_f32 v115, v59
    v_exp_f32 v116, v60
    v_exp_f32 v117, v61
    v_exp_f32 v118, v62
    v_exp_f32 v119, v63
    v_pk_fma_f32 v[120:121], v[112:113], -0.5, -1.0 op_sel_hi:[1,0,0]
    v_pk_fma_f32 v[122:123], v[114:115], -0.5, -1.0 op_sel_hi:[1,0,0]
    v_pk_fma_f32 v[124:125], v[116:117], -0.5, -1.0 op_sel_hi:[1,0,0]
    v_pk_fma_f32 v[126:127], v[118:119], -0.5, -1.0 op_sel_hi:[1,0,0]
    v_pk_fma_f32 v[112:113], v[112:113], v[120:121], -1.0 op_sel_hi:[1,1,0]
    v_pk_fma_f32 v[114:115], v[114:115], v[122:123], -1.0 op_sel_hi:[1,1,0]
    v_pk_fma_f32 v[116:117], v[116:117], v[124:125], -1.0 op_sel_hi:[1,1,0]
    v_pk_fma_f32 v[118:119], v[118:119], v[126:127], -1.0 op_sel_hi:[1,1,0]
    v_rcp_f32 v112, v112
    v_rcp_f32 v113, v113
    v_rcp_f32 v114, v114
    v_rcp_f32 v115, v115
    v_rcp_f32 v116, v116
    v_rcp_f32 v117, v117
    v_rcp_f32 v118, v118
    v_rcp_f32 v119, v119
    v_pk_fma_f32 v[112:113], v[56:57], v[112:113], v[56:57]
    v_pk_fma_f32 v[114:115], v[58:59], v[114:115], v[58:59]
    v_pk_fma_f32 v[116:117], v[60:61], v[116:117], v[60:61]
    v_pk_fma_f32 v[118:119], v[62:63], v[118:119], v[62:63]
    v_cvt_pk_bf16_f32 v56, v112, v113
    v_cvt_pk_bf16_f32 v57, v114, v115
    v_cvt_pk_bf16_f32 v58, v116, v117
    v_cvt_pk_bf16_f32 v59, v118, v119
    buffer_store_dwordx4 v[56:59], v3, s[44:47], s32 offen offset:1024 sc1
    s_add_u32 s32, s32, 57344
    v_pk_mul_f32 v[64:65], v[64:65], v[254:255] op_sel_hi:[1,0]
    v_pk_mul_f32 v[66:67], v[66:67], v[254:255] op_sel_hi:[1,0]
    v_pk_mul_f32 v[68:69], v[68:69], v[254:255] op_sel_hi:[1,0]
    v_pk_mul_f32 v[70:71], v[70:71], v[254:255] op_sel_hi:[1,0]
    v_exp_f32 v96, v64
    v_exp_f32 v97, v65
    v_exp_f32 v98, v66
    v_exp_f32 v99, v67
    v_exp_f32 v100, v68
    v_exp_f32 v101, v69
    v_exp_f32 v102, v70
    v_exp_f32 v103, v71
    s_waitcnt vmcnt(2)
    s_mov_b32 s51, 1
    s_atomic_add s51, s[30:31], s29
    s_add_u32 s29, s29, 256
    v_pk_fma_f32 v[104:105], v[96:97], -0.5, -1.0 op_sel_hi:[1,0,0]
    v_pk_fma_f32 v[106:107], v[98:99], -0.5, -1.0 op_sel_hi:[1,0,0]
    v_pk_fma_f32 v[108:109], v[100:101], -0.5, -1.0 op_sel_hi:[1,0,0]
    v_pk_fma_f32 v[110:111], v[102:103], -0.5, -1.0 op_sel_hi:[1,0,0]
    v_pk_fma_f32 v[96:97], v[96:97], v[104:105], -1.0 op_sel_hi:[1,1,0]
    v_pk_fma_f32 v[98:99], v[98:99], v[106:107], -1.0 op_sel_hi:[1,1,0]
    v_pk_fma_f32 v[100:101], v[100:101], v[108:109], -1.0 op_sel_hi:[1,1,0]
    v_pk_fma_f32 v[102:103], v[102:103], v[110:111], -1.0 op_sel_hi:[1,1,0]
    v_rcp_f32 v96, v96
    v_rcp_f32 v97, v97
    v_rcp_f32 v98, v98
    v_rcp_f32 v99, v99
    v_rcp_f32 v100, v100
    v_rcp_f32 v101, v101
    v_rcp_f32 v102, v102
    v_rcp_f32 v103, v103
    v_pk_fma_f32 v[96:97], v[64:65], v[96:97], v[64:65]
    v_pk_fma_f32 v[98:99], v[66:67], v[98:99], v[66:67]
    v_pk_fma_f32 v[100:101], v[68:69], v[100:101], v[68:69]
    v_pk_fma_f32 v[102:103], v[70:71], v[102:103], v[70:71]
    v_cvt_pk_bf16_f32 v64, v96, v97
    v_cvt_pk_bf16_f32 v65, v98, v99
    v_cvt_pk_bf16_f32 v66, v100, v101
    v_cvt_pk_bf16_f32 v67, v102, v103
    buffer_store_dwordx4 v[64:67], v3, s[44:47], s32 offen offset:0 sc1
    v_pk_mul_f32 v[72:73], v[72:73], v[254:255] op_sel_hi:[1,0]
    v_pk_mul_f32 v[74:75], v[74:75], v[254:255] op_sel_hi:[1,0]
    v_pk_mul_f32 v[76:77], v[76:77], v[254:255] op_sel_hi:[1,0]
    v_pk_mul_f32 v[78:79], v[78:79], v[254:255] op_sel_hi:[1,0]
    v_exp_f32 v112, v72
    v_exp_f32 v113, v73
    v_exp_f32 v114, v74
    v_exp_f32 v115, v75
    v_exp_f32 v116, v76
    v_exp_f32 v117, v77
    v_exp_f32 v118, v78
    v_exp_f32 v119, v79
    v_pk_fma_f32 v[120:121], v[112:113], -0.5, -1.0 op_sel_hi:[1,0,0]
    v_pk_fma_f32 v[122:123], v[114:115], -0.5, -1.0 op_sel_hi:[1,0,0]
    v_pk_fma_f32 v[124:125], v[116:117], -0.5, -1.0 op_sel_hi:[1,0,0]
    v_pk_fma_f32 v[126:127], v[118:119], -0.5, -1.0 op_sel_hi:[1,0,0]
    v_pk_fma_f32 v[112:113], v[112:113], v[120:121], -1.0 op_sel_hi:[1,1,0]
    v_pk_fma_f32 v[114:115], v[114:115], v[122:123], -1.0 op_sel_hi:[1,1,0]
    v_pk_fma_f32 v[116:117], v[116:117], v[124:125], -1.0 op_sel_hi:[1,1,0]
    v_pk_fma_f32 v[118:119], v[118:119], v[126:127], -1.0 op_sel_hi:[1,1,0]
    v_rcp_f32 v112, v112
    v_rcp_f32 v113, v113
    v_rcp_f32 v114, v114
    v_rcp_f32 v115, v115
    v_rcp_f32 v116, v116
    v_rcp_f32 v117, v117
    v_rcp_f32 v118, v118
    v_rcp_f32 v119, v119
    v_pk_fma_f32 v[112:113], v[72:73], v[112:113], v[72:73]
    v_pk_fma_f32 v[114:115], v[74:75], v[114:115], v[74:75]
    v_pk_fma_f32 v[116:117], v[76:77], v[116:117], v[76:77]
    v_pk_fma_f32 v[118:119], v[78:79], v[118:119], v[78:79]
    v_cvt_pk_bf16_f32 v72, v112, v113
    v_cvt_pk_bf16_f32 v73, v114, v115
    v_cvt_pk_bf16_f32 v74, v116, v117
    v_cvt_pk_bf16_f32 v75, v118, v119
    buffer_store_dwordx4 v[72:75], v3, s[44:47], s32 offen offset:1024 sc1
    s_nop 1
LXpost:
    v_mov_b32 v10, 9
    ds_write_b32 v8, v10
    buffer_load_dwordx4 v[144:147], v4, s[44:47], s76 offen offset:0 sc1
    buffer_load_dwordx4 v[148:151], v4, s[44:47], s76 offen offset:1024 sc1
    buffer_load_dwordx4 v[152:155], v4, s[44:47], s76 offen offset:2048 sc1
    buffer_load_dwordx4 v[156:159], v4, s[44:47], s76 offen offset:3072 sc1
    buffer_load_dwordx4 v[160:163], v4, s[44:47], s77 offen offset:0 sc1
    buffer_load_dwordx4 v[164:167], v4, s[44:47], s77 offen offset:1024 sc1
    s_waitcnt vmcnt(6)
    s_mov_b32 s51, 1
    s_atomic_add s51, s[30:31], s29
    buffer_load_dwordx4 v[168:171], v4, s[44:47], s77 offen offset:2048 sc1
    buffer_load_dwordx4 v[172:175], v4, s[44:47], s77 offen offset:3072 sc1
    buffer_load_dwordx4 v[176:179], v4, s[44:47], s78 offen offset:0 sc1
    buffer_load_dwordx4 v[180:183], v4, s[44:47], s78 offen offset:1024 sc1
    buffer_load_dwordx4 v[184:187], v4, s[44:47], s78 offen offset:2048 sc1
    buffer_load_dwordx4 v[188:191], v4, s[44:47], s78 offen offset:3072 sc1
    buffer_load_dwordx4 v[192:195], v4, s[44:47], s79 offen offset:0 sc1
    buffer_load_dwordx4 v[196:199], v4, s[44:47], s79 offen offset:1024 sc1
    buffer_load_dwordx4 v[200:203], v4, s[44:47], s79 offen offset:2048 sc1
    buffer_load_dwordx4 v[204:207], v4, s[44:47], s79 offen offset:3072 sc1
    s_load_dword s50, s[30:31], s48 glc
    buffer_load_dwordx4 v[208:211], v4, s[44:47], s80 offen offset:0 sc1
    buffer_load_dwordx4 v[212:215], v4, s[44:47], s80 offen offset:1024 sc1
    buffer_load_dwordx4 v[216:219], v4, s[44:47], s80 offen offset:2048 sc1
    buffer_load_dwordx4 v[220:223], v4, s[44:47], s80 offen offset:3072 sc1
    buffer_load_dwordx4 v[224:227], v4, s[44:47], s81 offen offset:0 sc1
    buffer_load_dwordx4 v[228:231], v4, s[44:47], s81 offen offset:1024 sc1
    buffer_load_dwordx4 v[232:235], v4, s[44:47], s81 offen offset:2048 sc1
    buffer_load_dwordx4 v[236:239], v4, s[44:47], s81 offen offset:3072 sc1
    buffer_load_dwordx4 v[240:243], v4, s[44:47], s82 offen offset:0 sc1
    buffer_load_dwordx4 v[244:247], v4, s[44:47], s82 offen offset:1024 sc1
    buffer_load_dwordx4 v[248:251], v4, s[44:47], s82 offen offset:2048 sc1
    buffer_load_dwordx4 v[252:255], v4, s[44:47], s82 offen offset:3072 sc1
    v_mov_b32 v10, 10
    ds_write_b32 v8, v10
    s_waitcnt lgkmcnt(0)
    s_cmp_lt_u32 s50, 14
    s_cbranch_scc1 Lretry5
Ldone5:
    buffer_load_dwordx4 v[80:83], v5, s[44:47], s83 offen sc1
    buffer_load_dwordx4 v[84:87], v5, s[44:47], s84 offen sc1
    buffer_load_dwordx4 v[88:91], v5, s[44:47], s85 offen sc1
    buffer_load_dwordx4 v[92:95], v5, s[44:47], s86 offen sc1
    buffer_load_dwordx4 v[96:99], v5, s[44:47], s87 offen sc1
    buffer_load_dwordx4 v[100:103], v5, s[44:47], s88 offen sc1
    buffer_load_dwordx4 v[104:107], v5, s[44:47], s89 offen sc1
    v_add_u32 v5, 57344, v5
    buffer_load_dwordx4 v[108:111], v5, s[44:47], s83 offen sc1
    buffer_load_dwordx4 v[112:115], v5, s[44:47], s84 offen sc1
    s_load_dword s50, s[30:31], s49 glc
    ds_read_b128 v[136:139], v11 offset:0
    s_waitcnt vmcnt(8)
    v_mfma_f32_16x16x32_bf16 v[16:19], v[144:147], v[80:83], 0
    v_and_b32 v12, 15, v1
    v_mfma_f32_16x16x32_bf16 v[20:23], v[148:151], v[80:83], 0
    v_lshrrev_b32 v117, 4, v1
    v_mfma_f32_16x16x32_bf16 v[24:27], v[152:155], v[80:83], 0
    v_xor_b32 v13, v12, v117
    v_mfma_f32_16x16x32_bf16 v[28:31], v[156:159], v[80:83], 0
    s_lshl_b32 s72, s67, 14
    buffer_load_dwordx4 v[80:83], v5, s[44:47], s85 offen sc1
    s_waitcnt vmcnt(8)
    v_mfma_f32_16x16x32_bf16 v[16:19], v[160:163], v[84:87], v[16:19]
    v_lshl_add_u32 v140, v12, 8, s72
    v_mfma_f32_16x16x32_bf16 v[20:23], v[164:167], v[84:87], v[20:23]
    v_lshl_add_u32 v140, v13, 4, v140
    v_mfma_f32_16x16x32_bf16 v[24:27], v[168:171], v[84:87], v[24:27]
    v_xor_b32 v141, 64, v140
    v_mfma_f32_16x16x32_bf16 v[28:31], v[172:175], v[84:87], v[28:31]
    v_xor_b32 v142, 128, v140
    buffer_load_dwordx4 v[84:87], v5, s[44:47], s86 offen sc1
    s_waitcnt vmcnt(8)
    v_mfma_f32_16x16x32_bf16 v[16:19], v[176:179], v[88:91], v[16:19]
    v_xor_b32 v143, 192, v140
    v_mfma_f32_16x16x32_bf16 v[20:23], v[180:183], v[88:91], v[20:23]
    s_lshl_b32 s70, s94, 4
    v_mfma_f32_16x16x32_bf16 v[24:27], v[184:187], v[88:91], v[24:27]
    v_add_u32 v116, s70, v12
    v_mfma_f32_16x16x32_bf16 v[28:31], v[188:191], v[88:91], v[28:31]
    s_lshr_b32 s71, s67, 2
    buffer_load_dwordx4 v[88:91], v5, s[44:47], s87 offen sc1
    s_waitcnt vmcnt(8)
    v_mfma_f32_16x16x32_bf16 v[16:19], v[192:195], v[92:95], v[16:19]
    s_lshl_b32 s72, s65, 16
    v_mfma_f32_16x16x32_bf16 v[20:23], v[196:199], v[92:95], v[20:23]
    s_lshl_b32 s73, s66, 7
    v_mfma_f32_16x16x32_bf16 v[24:27], v[200:203], v[92:95], v[24:27]
    s_add_u32 s72, s72, s73
    v_mfma_f32_16x16x32_bf16 v[28:31], v[204:207], v[92:95], v[28:31]
    s_lshl_b32 s73, s71, 6
    buffer_load_dwordx4 v[92:95], v5, s[44:47], s88 offen sc1
    s_waitcnt vmcnt(8)
    v_mfma_f32_16x16x32_bf16 v[16:19], v[208:211], v[96:99], v[16:19]
    s_add_u32 s72, s72, s73
    v_mfma_f32_16x16x32_bf16 v[20:23], v[212:215], v[96:99], v[20:23]
    v_lshl_add_u32 v118, v116, 10, s72
    v_mfma_f32_16x16x32_bf16 v[24:27], v[216:219], v[96:99], v[24:27]
    v_lshl_add_u32 v118, v117, 4, v118
    v_mfma_f32_16x16x32_bf16 v[28:31], v[220:223], v[96:99], v[28:31]
    s_lshl_b32 s72, s71, 3
    buffer_load_dwordx4 v[96:99], v5, s[44:47], s89 offen sc1
    s_waitcnt vmcnt(8)
    v_mfma_f32_16x16x32_bf16 v[16:19], v[224:227], v[100:103], v[16:19]
    v_lshl_add_u32 v13, v117, 1, s72
    v_mfma_f32_16x16x32_bf16 v[20:23], v[228:231], v[100:103], v[20:23]
    v_xor_b32 v13, v12, v13
    v_mfma_f32_16x16x32_bf16 v[24:27], v[232:235], v[100:103], v[24:27]
    v_lshlrev_b32 v124, 8, v116
    v_mfma_f32_16x16x32_bf16 v[28:31], v[236:239], v[100:103], v[28:31]
    v_lshl_add_u32 v124, v13, 4, v124
    s_waitcnt lgkmcnt(0)
    s_cmp_lt_u32 s50, 14
    s_cbranch_scc1 Lretry6
Ldone6:
    v_add_u32 v5, 57344, v5
    buffer_load_dwordx4 v[100:103], v5, s[44:47], s83 offen sc1
    s_waitcnt vmcnt(8)
    v_mfma_f32_16x16x32_bf16 v[16:19], v[240:243], v[104:107], v[16:19]
    v_xor_b32 v125, 16, v124
    v_mfma_f32_16x16x32_bf16 v[20:23], v[244:247], v[104:107], v[20:23]
    v_add_u32 v126, 0x10000, v124
    v_mfma_f32_16x16x32_bf16 v[24:27], v[248:251], v[104:107], v[24:27]
    v_add_u32 v127, 0x10000, v125
    v_mfma_f32_16x16x32_bf16 v[28:31], v[252:255], v[104:107], v[28:31]
    v_bfe_u32 v12, v1, 2, 2
    v_min_u32 v136, v136, v137
    v_min3_u32 v136, v136, v138, v139
    v_cmp_gt_u32 vcc, 10, v136
    s_nop 4
    s_cbranch_vccnz Lretry7
Ldone7:
    buffer_load_dwordx4 v[104:107], v5, s[44:47], s84 offen sc1
    s_waitcnt vmcnt(8)
    v_mfma_f32_16x16x32_bf16 v[32:35], v[144:147], v[108:111], 0
    v_lshl_add_u32 v12, v117, 3, v12
    v_mfma_f32_16x16x32_bf16 v[36:39], v[148:151], v[108:111], 0
    v_lshlrev_b32 v12, 7, v12
    v_mfma_f32_16x16x32_bf16 v[40:43], v[152:155], v[108:111], 0
    v_and_b32 v13, 3, v1
    v_mfma_f32_16x16x32_bf16 v[44:47], v[156:159], v[108:111], 0
    v_lshl_add_u32 v12, v13, 3, v12
    buffer_load_dwordx4 v[108:111], v5, s[44:47], s85 offen sc1
    s_waitcnt vmcnt(8)
    v_mfma_f32_16x16x32_bf16 v[32:35], v[160:163], v[112:115], v[32:35]
    s_lshl_b32 s72, s71, 12
    v_mfma_f32_16x16x32_bf16 v[36:39], v[164:167], v[112:115], v[36:39]
    s_lshl_b32 s73, s70, 1
    v_mfma_f32_16x16x32_bf16 v[40:43], v[168:171], v[112:115], v[40:43]
    s_add_u32 s72, s72, s73
    v_mfma_f32_16x16x32_bf16 v[44:47], v[172:175], v[112:115], v[44:47]
    s_add_u32 s72, s72, 147968
    ds_write_b128 v140, v[16:19] offset:0
    buffer_load_dwordx4 v[112:115], v5, s[44:47], s86 offen sc1
    s_waitcnt vmcnt(8)
    v_mfma_f32_16x16x32_bf16 v[32:35], v[176:179], v[80:83], v[32:35]
    v_add_u32 v119, s72, v12
    v_mfma_f32_16x16x32_bf16 v[36:39], v[180:183], v[80:83], v[36:39]
    s_lshr_b32 s72, s65, 2
    v_mfma_f32_16x16x32_bf16 v[40:43], v[184:187], v[80:83], v[40:43]
    s_lshr_b32 s73, s72, 1
    v_mfma_f32_16x16x32_bf16 v[44:47], v[188:191], v[80:83], v[44:47]
    s_xor_b32 s72, s72, s73
    ds_write_b128 v141, v[20:23] offset:0
    buffer_load_dwordx4 v[80:83], v5, s[44:47], s87 offen sc1
    s_waitcnt vmcnt(8)
    v_mfma_f32_16x16x32_bf16 v[32:35], v[192:195], v[84:87], v[32:35]
    s_and_b32 s72, s72, 1
    v_mfma_f32_16x16x32_bf16 v[36:39], v[196:199], v[84:87], v[36:39]
    s_lshl_b32 s73, s66, 1
    v_mfma_f32_16x16x32_bf16 v[40:43], v[200:203], v[84:87], v[40:43]
    s_add_u32 s72, s72, s73
    v_mfma_f32_16x16x32_bf16 v[44:47], v[204:207], v[84:87], v[44:47]
    s_lshl_b32 s72, s72, 2
    ds_write_b128 v142, v[24:27] offset:0
    buffer_load_dwordx4 v[84:87], v5, s[44:47], s88 offen sc1
    s_waitcnt vmcnt(8)
    v_mfma_f32_16x16x32_bf16 v[32:35], v[208:211], v[88:91], v[32:35]
    s_add_u32 s72, s72, s67
    v_mfma_f32_16x16x32_bf16 v[36:39], v[212:215], v[88:91], v[36:39]
    s_lshl_b32 s72, s72, 7
    v_mfma_f32_16x16x32_bf16 v[40:43], v[216:219], v[88:91], v[40:43]
    s_add_u32 s48, s72, 802816
    v_mfma_f32_16x16x32_bf16 v[44:47], v[220:223], v[88:91], v[44:47]
    v_lshrrev_b32 v12, 3, v0
    ds_write_b128 v143, v[28:31] offset:0
    buffer_load_dwordx4 v[88:91], v5, s[44:47], s89 offen sc1
    s_waitcnt vmcnt(8)
    v_mfma_f32_16x16x32_bf16 v[32:35], v[224:227], v[92:95], v[32:35]
    v_and_b32 v13, 7, v0
    v_mfma_f32_16x16x32_bf16 v[36:39], v[228:231], v[92:95], v[36:39]
    v_mul_u32_u24 v128, 4352, v12
    v_mfma_f32_16x16x32_bf16 v[40:43], v[232:235], v[92:95], v[40:43]
    v_lshl_add_u32 v128, v13, 4, v128
    v_mfma_f32_16x16x32_bf16 v[44:47], v[236:239], v[92:95], v[44:47]
    s_mul_i32 s72, s66, 278528
    v_add_u32 v5, 57344, v5
    buffer_load_dwordx4 v[92:95], v5, s[44:47], s83 offen sc1
    s_waitcnt vmcnt(8)
    v_mfma_f32_16x16x32_bf16 v[32:35], v[240:243], v[96:99], v[32:35]
    s_lshl_b32 s73, s65, 7
    v_mfma_f32_16x16x32_bf16 v[36:39], v[244:247], v[96:99], v[36:39]
    s_add_u32 s72, s72, s73
    v_mfma_f32_16x16x32_bf16 v[40:43], v[248:251], v[96:99], v[40:43]
    s_add_u32 s72, s72, 5242880
    v_mfma_f32_16x16x32_bf16 v[44:47], v[252:255], v[96:99], v[44:47]
    s_add_u32 s73, s72, 139264
    buffer_load_dwordx4 v[96:99], v5, s[44:47], s84 offen sc1
    s_waitcnt vmcnt(8)
    v_mfma_f32_16x16x32_bf16 v[48:51], v[144:147], v[100:103], 0
    v_lshlrev_b32 v129, 4, v0
    v_mfma_f32_16x16x32_bf16 v[52:55], v[148:151], v[100:103], 0
    v_add_u32 v129, 147968, v129
    v_mfma_f32_16x16x32_bf16 v[56:59], v[152:155], v[100:103], 0
    v_mfma_f32_16x16x32_bf16 v[60:63], v[156:159], v[100:103], 0
    buffer_load_dwordx4 v[100:103], v5, s[44:47], s85 offen sc1
    s_waitcnt vmcnt(8)
    v_mfma_f32_16x16x32_bf16 v[48:51], v[160:163], v[104:107], v[48:51]
    v_mfma_f32_16x16x32_bf16 v[52:55], v[164:167], v[104:107], v[52:55]
    v_mfma_f32_16x16x32_bf16 v[56:59], v[168:171], v[104:107], v[56:59]
    v_mfma_f32_16x16x32_bf16 v[60:63], v[172:175], v[104:107], v[60:63]
    ds_write_b128 v140, v[32:35] offset:4096
    buffer_load_dwordx4 v[104:107], v5, s[44:47], s86 offen sc1
    s_waitcnt vmcnt(8)
    v_mfma_f32_16x16x32_bf16 v[48:51], v[176:179], v[108:111], v[48:51]
    v_mfma_f32_16x16x32_bf16 v[52:55], v[180:183], v[108:111], v[52:55]
    v_mfma_f32_16x16x32_bf16 v[56:59], v[184:187], v[108:111], v[56:59]
    v_mfma_f32_16x16x32_bf16 v[60:63], v[188:191], v[108:111], v[60:63]
    ds_write_b128 v141, v[36:39] offset:4096
    buffer_load_dwordx4 v[108:111], v5, s[44:47], s87 offen sc1
    s_waitcnt vmcnt(8)
    v_mfma_f32_16x16x32_bf16 v[48:51], v[192:195], v[112:115], v[48:51]
    v_mfma_f32_16x16x32_bf16 v[52:55], v[196:199], v[112:115], v[52:55]
    v_mfma_f32_16x16x32_bf16 v[56:59], v[200:203], v[112:115], v[56:59]
    v_mfma_f32_16x16x32_bf16 v[60:63], v[204:207], v[112:115], v[60:63]
    ds_write_b128 v142, v[40:43] offset:4096
    buffer_load_dwordx4 v[112:115], v5, s[44:47], s88 offen sc1
    s_waitcnt vmcnt(8)
    v_mfma_f32_16x16x32_bf16 v[48:51], v[208:211], v[80:83], v[48:51]
    v_mfma_f32_16x16x32_bf16 v[52:55], v[212:215], v[80:83], v[52:55]
    v_mfma_f32_16x16x32_bf16 v[56:59], v[216:219], v[80:83], v[56:59]
    v_mfma_f32_16x16x32_bf16 v[60:63], v[220:223], v[80:83], v[60:63]
    ds_write_b128 v143, v[44:47] offset:4096
    buffer_load_dwordx4 v[80:83], v5, s[44:47], s89 offen sc1
    global_load_dwordx4 v[120:123], v118, s[4:5]
    s_waitcnt vmcnt(9)
    v_mfma_f32_16x16x32_bf16 v[48:51], v[224:227], v[84:87], v[48:51]
    v_mfma_f32_16x16x32_bf16 v[52:55], v[228:231], v[84:87], v[52:55]
    v_mfma_f32_16x16x32_bf16 v[56:59], v[232:235], v[84:87], v[56:59]
    v_mfma_f32_16x16x32_bf16 v[60:63], v[236:239], v[84:87], v[60:63]
    s_waitcnt vmcnt(8)
    v_mfma_f32_16x16x32_bf16 v[48:51], v[240:243], v[88:91], v[48:51]
    v_mfma_f32_16x16x32_bf16 v[52:55], v[244:247], v[88:91], v[52:55]
    v_mfma_f32_16x16x32_bf16 v[56:59], v[248:251], v[88:91], v[56:59]
    v_mfma_f32_16x16x32_bf16 v[60:63], v[252:255], v[88:91], v[60:63]
    s_waitcnt vmcnt(7)
    v_mfma_f32_16x16x32_bf16 v[64:67], v[144:147], v[92:95], 0
    v_mfma_f32_16x16x32_bf16 v[68:71], v[148:151], v[92:95], 0
    v_mfma_f32_16x16x32_bf16 v[72:75], v[152:155], v[92:95], 0
    v_mfma_f32_16x16x32_bf16 v[76:79], v[156:159], v[92:95], 0
    s_waitcnt vmcnt(6)
    v_mfma_f32_16x16x32_bf16 v[64:67], v[160:163], v[96:99], v[64:67]
    v_mfma_f32_16x16x32_bf16 v[68:71], v[164:167], v[96:99], v[68:71]
    v_mfma_f32_16x16x32_bf16 v[72:75], v[168:171], v[96:99], v[72:75]
    v_mfma_f32_16x16x32_bf16 v[76:79], v[172:175], v[96:99], v[76:79]
    ds_write_b128 v140, v[48:51] offset:8192
    s_waitcnt vmcnt(5)
    v_mfma_f32_16x16x32_bf16 v[64:67], v[176:179], v[100:103], v[64:67]
    v_mfma_f32_16x16x32_bf16 v[68:71], v[180:183], v[100:103], v[68:71]
    v_mfma_f32_16x16x32_bf16 v[72:75], v[184:187], v[100:103], v[72:75]
    v_mfma_f32_16x16x32_bf16 v[76:79], v[188:191], v[100:103], v[76:79]
    ds_write_b128 v141, v[52:55] offset:8192
    s_load_dword s50, s[30:31], s48 glc
    ds_read_b128 v[132:135], v11 offset:16
    s_waitcnt vmcnt(4)
    v_mfma_f32_16x16x32_bf16 v[64:67], v[192:195], v[104:107], v[64:67]
    v_mfma_f32_16x16x32_bf16 v[68:71], v[196:199], v[104:107], v[68:71]
    v_mfma_f32_16x16x32_bf16 v[72:75], v[200:203], v[104:107], v[72:75]
    v_mfma_f32_16x16x32_bf16 v[76:79], v[204:207], v[104:107], v[76:79]
    ds_write_b128 v142, v[56:59] offset:8192
    s_waitcnt vmcnt(3)
    v_mfma_f32_16x16x32_bf16 v[64:67], v[208:211], v[108:111], v[64:67]
    v_mfma_f32_16x16x32_bf16 v[68:71], v[212:215], v[108:111], v[68:71]
    v_mfma_f32_16x16x32_bf16 v[72:75], v[216:219], v[108:111], v[72:75]
    v_mfma_f32_16x16x32_bf16 v[76:79], v[220:223], v[108:111], v[76:79]
    ds_write_b128 v143, v[60:63] offset:8192
    s_waitcnt vmcnt(2)
    v_mfma_f32_16x16x32_bf16 v[64:67], v[224:227], v[112:115], v[64:67]
    v_mfma_f32_16x16x32_bf16 v[68:71], v[228:231], v[112:115], v[68:71]
    v_mfma_f32_16x16x32_bf16 v[72:75], v[232:235], v[112:115], v[72:75]
    v_mfma_f32_16x16x32_bf16 v[76:79], v[236:239], v[112:115], v[76:79]
    s_waitcnt vmcnt(1)
    v_mfma_f32_16x16x32_bf16 v[64:67], v[240:243], v[80:83], v[64:67]
    v_mfma_f32_16x16x32_bf16 v[68:71], v[244:247], v[80:83], v[68:71]
    v_mfma_f32_16x16x32_bf16 v[72:75], v[248:251], v[80:83], v[72:75]
    v_mfma_f32_16x16x32_bf16 v[76:79], v[252:255], v[80:83], v[76:79]
    s_waitcnt lgkmcnt(0)
    s_cmp_lt_u32 s50, 16
    s_cbranch_scc1 Lretry8
Ldone8:
    buffer_load_dwordx4 v[160:163], v128, s[44:47], s72 offen sc1
    buffer_load_dwordx4 v[172:175], v128, s[44:47], s73 offen sc1
    ds_write_b128 v140, v[64:67] offset:12288
    ds_write_b128 v141, v[68:71] offset:12288
    ds_write_b128 v142, v[72:75] offset:12288
    ds_write_b128 v143, v[76:79] offset:12288
    v_min_u32 v132, v132, v133
    v_min3_u32 v132, v132, v134, v135
    v_cmp_gt_u32 vcc, 13, v132
    s_nop 4
    s_cbranch_vccnz Lretry9
Ldone9:
    s_waitcnt vmcnt(1)
    ds_write_b128 v129, v[160:163]
    s_waitcnt vmcnt(0)
    ds_write_b128 v129, v[172:175] offset:4096
    s_waitcnt vmcnt(0) lgkmcnt(0)
    s_branch Lfinal
LXspare:
    s_barrier
    s_barrier
    s_barrier
    s_barrier
    v_mov_b32 v10, 9
    ds_write_b32 v8, v10
    s_lshl_b32 s29, s62, 7
    s_add_u32 s29, s29, 786496
    s_waitcnt vmcnt(0) lgkmcnt(0)
    s_branch LXpost
LYs:
    s_waitcnt lgkmcnt(0)
    s_barrier
    s_lshl_b32 s72, s62, 2
    s_load_dword s3, s[30:31], 0
    s_load_dword s92, s[14:15], s72
    s_load_dword s93, s[16:17], s72
    s_cmp_lg_u32 s94, 0
    s_cbranch_scc1 Lnoinit10
    s_lshl_b32 s72, s62, 7
    s_add_u32 s72, s72, 786432
    s_mov_b32 s51, 0
    s_atomic_swap s51, s[30:31], s72
Lnoinit10:
    s_mov_b32 s44, s30
    s_mov_b32 s45, s31
    s_mov_b32 s46, 16777216
    s_mov_b32 s47, 0x20000
    v_lshlrev_b32 v3, 4, v1
    v_and_b32 v12, 255, v0
    s_and_b32 s73, s61, 3
    s_lshl_b32 s65, s60, 2
    s_add_u32 s65, s65, s73
    s_lshr_b32 s19, s94, 1
    v_bfe_u32 v18, v1, 2, 2
    v_and_b32 v19, 3, v1
    v_lshlrev_b32 v76, 10, v18
    v_lshl_add_u32 v76, v19, 3, v76
    v_lshrrev_b32 v77, 4, v12
    v_lshl_add_u32 v76, v77, 5, v76
    v_add_u32 v76, 147968, v76
    v_lshrrev_b32 v79, 5, v1
    v_bfe_u32 v78, v1, 4, 1
    v_lshl_add_u32 v77, v79, 2, v18
    v_lshlrev_b32 v77, 7, v77
    v_lshl_add_u32 v77, v19, 3, v77
    v_lshl_add_u32 v77, v78, 5, v77
    v_add_u32 v77, s95, v77
    v_and_b32 v72, 15, v1
    v_lshlrev_b32 v72, 4, v72
    v_lshl_add_u32 v72, v79, 8, v72
    v_lshl_add_u32 v72, v78, 10, v72
    v_lshlrev_b32 v78, 4, v12
    v_and_b32 v79, 7, v1
    v_lshl_add_u32 v75, v79, 2, v11
    v_lshlrev_b32 v79, 3, v79
    s_lshl_b32 s70, s62, 6
    s_add_u32 s70, s70, 16384
    s_cmp_lg_u32 s94, 0
    s_cselect_b32 s24, 16777216, s70
    s_mul_i32 s71, s62, 8448
    s_add_u32 s22, s71, 1048576
    s_add_u32 s23, s22, 4096
    s_waitcnt lgkmcnt(0)
    v_cmp_gt_u32 s[14:15], 32, v1
    s_mul_i32 s3, s3, 0x9E3779B1
    s_add_u32 s3, s3, 0x3C6EF35F
    v_mov_b32 v2, s3
    s_lshl_b32 s73, s19, 4
    s_lshr_b32 s93, s93, s73
    s_lshl_b32 s93, s93, 16
    s_lshr_b32 s92, s92, s73
    s_lshl_b32 s92, s92, 16
    v_mov_b32 v71, v2
    ds_read_b128 v[48:51], v11 offset:0
    s_waitcnt lgkmcnt(0)
    v_min_u32 v48, v48, v49
    v_min3_u32 v48, v48, v50, v51
    v_cmp_gt_u32 vcc, 1, v48
    s_nop 4
    s_cbranch_vccnz Lretry11
Ldone11:
    ds_read_b64_tr_b16 v[32:33], v76 offset:0
    ds_read_b64_tr_b16 v[34:35], v76 offset:4096
    ds_read_b64_tr_b16 v[36:37], v76 offset:512
    ds_read_b64_tr_b16 v[38:39], v76 offset:4608
    ds_read_b32 v70, v75 offset:32
    v_mov_b32 v10, 1
    ds_write_b32 v8, v10
    s_waitcnt lgkmcnt(4)
    buffer_store_dwordx4 v[32:35], v78, s[44:47], s22 offen sc1
    s_waitcnt lgkmcnt(2)
    buffer_store_dwordx4 v[36:39], v78, s[44:47], s23 offen sc1
    s_waitcnt lgkmcnt(1)
    s_cmp_lg_u32 s94, 0
    s_cbranch_scc1 Lnst12
    buffer_store_dwordx2 v[70:71], v79, s[44:47], s24 offen sc1
Lnst12:
    s_lshr_b32 s36, s60, 1
    s_lshl_b32 s36, s36, 2
    s_add_u32 s36, s36, s61
    s_sub_u32 s36, s36, 28
    s_min_u32 s36, s36, 13
    s_and_b32 s37, s60, 1
    s_mul_i32 s37, s37, 14
    s_add_u32 s36, s36, s37
    s_mov_b32 s40, s20
    s_mov_b32 s41, s21
    s_mov_b32 s42, 1835008
    v_lshrrev_b32 v244, 3, v1
    v_mul_u32_u24 v244, 3584, v244
    v_and_b32 v245, 7, v1
    v_lshl_add_u32 v244, v245, 4, v244
    s_mul_i32 s37, s94, 458752
    s_lshl_b32 s68, s36, 7
    s_add_u32 s37, s37, s68
    s_lshl_b32 s69, s94, 14
    s_add_u32 m0, s69, 0
    s_nop 0
    buffer_load_dwordx4 v244, s[40:43], s37 offen lds
    s_add_u32 m0, s69, 1024
    s_add_u32 s37, s37, 28672
    buffer_load_dwordx4 v244, s[40:43], s37 offen lds
    s_add_u32 m0, s69, 2048
    s_add_u32 s37, s37, 28672
    buffer_load_dwordx4 v244, s[40:43], s37 offen lds
    s_add_u32 m0, s69, 3072
    s_add_u32 s37, s37, 28672
    buffer_load_dwordx4 v244, s[40:43], s37 offen lds
    s_add_u32 m0, s69, 4096
    s_add_u32 s37, s37, 28672
    buffer_load_dwordx4 v244, s[40:43], s37 offen lds
    s_add_u32 m0, s69, 5120
    s_add_u32 s37, s37, 28672
    buffer_load_dwordx4 v244, s[40:43], s37 offen lds
    s_add_u32 m0, s69, 6144
    s_add_u32 s37, s37, 28672
    buffer_load_dwordx4 v244, s[40:43], s37 offen lds
    s_add_u32 m0, s69, 7168
    s_add_u32 s37, s37, 28672
    buffer_load_dwordx4 v244, s[40:43], s37 offen lds
    s_add_u32 m0, s69, 8192
    s_add_u32 s37, s37, 28672
    buffer_load_dwordx4 v244, s[40:43], s37 offen lds
    s_add_u32 m0, s69, 9216
    s_add_u32 s37, s37, 28672
    buffer_load_dwordx4 v244, s[40:43], s37 offen lds
    s_add_u32 m0, s69, 10240
    s_add_u32 s37, s37, 28672
    buffer_load_dwordx4 v244, s[40:43], s37 offen lds
    s_add_u32 m0, s69, 11264
    s_add_u32 s37, s37, 28672
    buffer_load_dwordx4 v244, s[40:43], s37 offen lds
    s_add_u32 m0, s69, 12288
    s_add_u32 s37, s37, 28672
    buffer_load_dwordx4 v244, s[40:43], s37 offen lds
    s_add_u32 m0, s69, 13312
    s_add_u32 s37, s37, 28672
    buffer_load_dwordx4 v244, s[40:43], s37 offen lds
    s_add_u32 m0, s69, 14336
    s_add_u32 s37, s37, 28672
    buffer_load_dwordx4 v244, s[40:43], s37 offen lds
    s_add_u32 m0, s69, 15360
    s_add_u32 s37, s37, 28672
    buffer_load_dwordx4 v244, s[40:43], s37 offen lds
    s_add_u32 s8, s34, Ltab-Lpc
    s_addc_u32 s9, s35, 0
    v_and_b32 v16, 127, v0
    v_lshlrev_b32 v16, 5, v16
    v_mov_b32 v59, v16
    s_mul_i32 s73, s19, 6656
    s_add_u32 s73, s73, 147968
    v_mov_b32 v74, s73
    s_mul_i32 s73, s19, 16640
    s_add_u32 s73, s73, 98304
    v_add_u32 v16, s73, v16
    v_lshrrev_b32 v17, 1, v12
    v_and_b32 v18, 1, v12
    v_mul_u32_u24 v30, 8448, v17
    v_lshl_add_u32 v30, v18, 4, v30
    v_mul_u32_u24 v18, 4576, v18
    v_lshl_add_u32 v18, v17, 4, v18
    v_add_u32 v31, 132064, v18
    v_lshlrev_b32 v61, 6, v12
    v_add_u32 v61, 163840, v61
    v_mov_b32 v52, 0
    v_mov_b32 v53, 0
    v_mov_b32 v54, 0
    v_mov_b32 v55, 0
    v_bfe_u32 v17, v1, 2, 3
    v_mul_u32_u24 v17, 4160, v17
    v_and_b32 v19, 3, v1
    v_lshl_add_u32 v17, v19, 4, v17
    v_add_u32 v57, 102400, v17
    v_lshrrev_b32 v17, 5, v1
    v_mul_u32_u24 v17, 4576, v17
    v_and_b32 v19, 31, v1
    v_min_u32 v19, 29, v19
    v_lshl_add_u32 v17, v19, 4, v17
    v_add_u32 v58, 131584, v17
    v_and_b32 v56, 15, v1
    v_lshrrev_b32 v17, 4, v1
    v_sub_u32 v18, 15, v56
    v_and_b32 v19, 3, v18
    v_mul_u32_u24 v19, 4160, v19
    v_lshrrev_b32 v18, 2, v18
    v_lshl_add_u32 v19, v18, 3, v19
    v_lshl_add_u32 v19, v17, 4, v19
    s_and_b32 s95, s94, 1
    s_lshl_b32 s95, s95, 8
    s_sub_u32 s73, s73, s95
    v_add_u32 v136, s73, v19
    s_mul_i32 s73, s19, 4576
    s_add_u32 s73, s73, 131840
    s_sub_u32 s73, s73, s95
    v_lshlrev_b32 v19, 5, v56
    v_lshl_add_u32 v19, v17, 4, v19
    v_add_u32 v137, s73, v19
    v_lshrrev_b32 v18, 1, v17
    v_lshlrev_b32 v138, 5, v56
    v_lshl_add_u32 v138, v18, 4, v138
    v_and_b32 v142, 1, v17
    s_lshl_b32 s73, s94, 12
    s_add_u32 s73, s73, 140736
    v_add_u32 v139, s73, v3
    s_xor_b32 s73, s94, 1
    s_lshl_b32 s73, s73, 12
    s_add_u32 s73, s73, 140736
    v_add_u32 v140, s73, v3
    s_and_b32 s71, s61, 3
    s_lshl_b32 s71, s71, 1
    s_add_u32 s70, s66, s71
    s_sub_u32 s71, s70, 7
    s_min_u32 s70, s70, s71
    s_lshl_b32 s76, s70, 12
    s_add_u32 s70, s76, 4096
    s_sub_u32 s71, s70, 28672
    s_min_u32 s77, s70, s71
    s_add_u32 s70, s76, 8192
    s_sub_u32 s71, s70, 28672
    s_min_u32 s78, s70, s71
    s_add_u32 s70, s76, 12288
    s_sub_u32 s71, s70, 28672
    s_min_u32 s79, s70, s71
    s_add_u32 s70, s76, 16384
    s_sub_u32 s71, s70, 28672
    s_min_u32 s80, s70, s71
    s_add_u32 s70, s76, 20480
    s_sub_u32 s71, s70, 28672
    s_min_u32 s81, s70, s71
    s_add_u32 s70, s76, 24576
    s_sub_u32 s71, s70, 28672
    s_min_u32 s82, s70, s71
    s_lshr_b32 s83, s76, 2
    s_lshr_b32 s84, s77, 2
    s_lshr_b32 s85, s78, 2
    s_lshr_b32 s86, s79, 2
    s_lshr_b32 s87, s80, 2
    s_lshr_b32 s88, s81, 2
    s_lshr_b32 s89, s82, 2
    s_and_b32 s96, s66, 1
    s_lshl_b32 s96, s96, 2
    s_xor_b32 s96, s96, s67
    s_mul_i32 s71, s96, 28672
    s_mul_i32 s70, s66, 229376
    s_add_u32 s70, s70, s71
    s_add_u32 s70, s70, 3407872
    v_add_u32 v4, s70, v3
    s_mul_i32 s70, s65, 229376
    s_lshr_b32 s71, s71, 2
    s_add_u32 s70, s70, s71
    s_add_u32 s70, s70, 7602176
    v_add_u32 v5, s70, v3
    s_lshr_b32 s70, s96, 2
    s_lshl_b32 s71, s65, 2
    s_add_u32 s70, s70, s71
    s_lshl_b32 s70, s70, 7
    s_add_u32 s48, s70, 786432
    s_add_u32 s49, s48, 256
    s_lshl_b32 s6, s62, 5
    s_add_u32 s6, s6, 1048576
    s_add_u32 s7, s6, 1081344
    s_lshl_b32 s28, s62, 6
    s_add_u32 s28, s28, 163840
    global_load_dwordx4 v[20:23], v59, s[8:9]
    global_load_dwordx4 v[24:27], v59, s[8:9] offset:16
    global_load_dwordx2 v[28:29], v59, s[8:9] offset:32
    s_waitcnt vmcnt(19)
    v_mov_b32 v63, 1
    s_mov_b64 exec, 1
    ds_add_rtn_u32 v63, v11, v63 offset:64
    s_mov_b64 exec, -1
    s_waitcnt lgkmcnt(0)
    v_readfirstlane_b32 s70, v63
    s_mov_b32 s51, s3
    s_nop 2
    s_cmp_lg_u32 s70, 3
    s_cbranch_scc1 Lnof13
    s_atomic_swap s51, s[30:31], s28
Lnof13:
    v_bfe_u32 v246, v1, 2, 2
    v_lshrrev_b32 v247, 5, v1
    v_lshl_add_u32 v246, v247, 3, v246
    v_lshlrev_b32 v246, 7, v246
    v_and_b32 v247, 3, v1
    v_lshl_add_u32 v246, v247, 3, v246
    v_bfe_u32 v247, v1, 4, 1
    v_lshl_add_u32 v246, v247, 5, v246
    v_add_u32 v246, s69, v246
    v_mov_b32 v144, 0x3f803f80
    v_mov_b32 v145, 0x3f803f80
    v_mov_b32 v146, 0x3f803f80
    v_mov_b32 v147, 0x3f803f80
    s_lshl_b32 s68, s36, 11
    s_lshl_b32 s37, s94, 3
    s_add_u32 s68, s68, s37
    s_add_u32 s68, s68, 32768
    v_lshlrev_b32 v247, 5, v1
    s_waitcnt vmcnt(17)
    ds_read_b64_tr_b16 v[148:149], v246 offset:0
    ds_read_b64_tr_b16 v[150:151], v246 offset:512
    ds_read_b64_tr_b16 v[152:153], v246 offset:64
    ds_read_b64_tr_b16 v[154:155], v246 offset:576
    s_waitcnt lgkmcnt(2)
    v_mfma_f32_32x32x16_bf16 v[176:191], v[144:147], v[148:151], 0
    s_waitcnt lgkmcnt(0)
    v_mfma_f32_32x32x16_bf16 v[192:207], v[144:147], v[152:155], 0
    s_waitcnt vmcnt(15)
    ds_read_b64_tr_b16 v[156:157], v246 offset:2048
    ds_read_b64_tr_b16 v[158:159], v246 offset:2560
    ds_read_b64_tr_b16 v[160:161], v246 offset:2112
    ds_read_b64_tr_b16 v[162:163], v246 offset:2624
    s_waitcnt lgkmcnt(2)
    v_mfma_f32_32x32x16_bf16 v[176:191], v[144:147], v[156:159], v[176:191]
    s_waitcnt lgkmcnt(0)
    v_mfma_f32_32x32x16_bf16 v[192:207], v[144:147], v[160:163], v[192:207]
    s_waitcnt vmcnt(13)
    ds_read_b64_tr_b16 v[148:149], v246 offset:4096
    ds_read_b64_tr_b16 v[150:151], v246 offset:4608
    ds_read_b64_tr_b16 v[152:153], v246 offset:4160
    ds_read_b64_tr_b16 v[154:155], v246 offset:4672
    s_waitcnt lgkmcnt(2)
    v_mfma_f32_32x32x16_bf16 v[176:191], v[144:147], v[148:151], v[176:191]
    s_waitcnt lgkmcnt(0)
    v_mfma_f32_32x32x16_bf16 v[192:207], v[144:147], v[152:155], v[192:207]
    s_waitcnt vmcnt(11)
    ds_read_b64_tr_b16 v[156:157], v246 offset:6144
    ds_read_b64_tr_b16 v[158:159], v246 offset:6656
    ds_read_b64_tr_b16 v[160:161], v246 offset:6208
    ds_read_b64_tr_b16 v[162:163], v246 offset:6720
    s_waitcnt lgkmcnt(2)
    v_mfma_f32_32x32x16_bf16 v[176:191], v[144:147], v[156:159], v[176:191]
    s_waitcnt lgkmcnt(0)
    v_mfma_f32_32x32x16_bf16 v[192:207], v[144:147], v[160:163], v[192:207]
    s_waitcnt vmcnt(9)
    ds_read_b64_tr_b16 v[148:149], v246 offset:8192
    ds_read_b64_tr_b16 v[150:151], v246 offset:8704
    ds_read_b64_tr_b16 v[152:153], v246 offset:8256
    ds_read_b64_tr_b16 v[154:155], v246 offset:8768
    s_waitcnt lgkmcnt(2)
    v_mfma_f32_32x32x16_bf16 v[176:191], v[144:147], v[148:151], v[176:191]
    s_waitcnt lgkmcnt(0)
    v_mfma_f32_32x32x16_bf16 v[192:207], v[144:147], v[152:155], v[192:207]
    s_waitcnt vmcnt(7)
    ds_read_b64_tr_b16 v[156:157], v246 offset:10240
    ds_read_b64_tr_b16 v[158:159], v246 offset:10752
    ds_read_b64_tr_b16 v[160:161], v246 offset:10304
    ds_read_b64_tr_b16 v[162:163], v246 offset:10816
    s_waitcnt lgkmcnt(2)
    v_mfma_f32_32x32x16_bf16 v[176:191], v[144:147], v[156:159], v[176:191]
    s_waitcnt lgkmcnt(0)
    v_mfma_f32_32x32x16_bf16 v[192:207], v[144:147], v[160:163], v[192:207]
    s_waitcnt vmcnt(5)
    ds_read_b64_tr_b16 v[148:149], v246 offset:12288
    ds_read_b64_tr_b16 v[150:151], v246 offset:12800
    ds_read_b64_tr_b16 v[152:153], v246 offset:12352
    ds_read_b64_tr_b16 v[154:155], v246 offset:12864
    s_waitcnt lgkmcnt(2)
    v_mfma_f32_32x32x16_bf16 v[176:191], v[144:147], v[148:151], v[176:191]
    s_waitcnt lgkmcnt(0)
    v_mfma_f32_32x32x16_bf16 v[192:207], v[144:147], v[152:155], v[192:207]
    s_waitcnt vmcnt(3)
    ds_read_b64_tr_b16 v[156:157], v246 offset:14336
    ds_read_b64_tr_b16 v[158:159], v246 offset:14848
    ds_read_b64_tr_b16 v[160:161], v246 offset:14400
    ds_read_b64_tr_b16 v[162:163], v246 offset:14912
    s_waitcnt lgkmcnt(2)
    v_mfma_f32_32x32x16_bf16 v[176:191], v[144:147], v[156:159], v[176:191]
    s_waitcnt lgkmcnt(0)
    v_mfma_f32_32x32x16_bf16 v[192:207], v[144:147], v[160:163], v[192:207]
    s_nop 11
    v_cndmask_b32 v164, v192, v176, s[14:15]
    v_mov_b32 v165, v2
    buffer_store_dwordx2 v[164:165], v247, s[44:47], s68 offen sc1
    s_barrier
    s_barrier
    s_barrier
    s_barrier
    global_load_dword v60, v61, s[30:31] sc1
    s_waitcnt vmcnt(0)
    v_cmp_ne_u32 vcc, s3, v60
    s_nop 4
    s_cbranch_vccnz Lretry14
Ldone14:
    s_barrier
    s_waitcnt vmcnt(0)
LYjoin:
    s_setprio 1
    ds_read_b128 v[64:67], v11 offset:0
    s_waitcnt lgkmcnt(0)
    v_min_u32 v64, v64, v65
    v_min3_u32 v64, v64, v66, v67
    v_cmp_gt_u32 vcc, 6, v64
    s_nop 4
    s_cbranch_vccnz Lretry20
Ldone20:
    buffer_load_dwordx4 v[128:131], v30, s[44:47], s6 offen sc1
    buffer_load_dwordx4 v[132:135], v30, s[44:47], s7 offen sc1
    buffer_load_dwordx4 v[144:147], v4, s[44:47], s76 offen offset:0 sc1
    buffer_load_dwordx4 v[148:151], v4, s[44:47], s76 offen offset:1024 sc1
    s_waitcnt vmcnt(4)
    v_mov_b32 v10, 9
    ds_write_b32 v8, v10
    buffer_load_dwordx4 v[152:155], v4, s[44:47], s76 offen offset:2048 sc1
    v_add_u32_sdwa v32, v20, v74 dst_sel:DWORD dst_unused:UNUSED_PAD src0_sel:WORD_0 src1_sel:DWORD
    v_add_u32_sdwa v33, v20, v74 dst_sel:DWORD dst_unused:UNUSED_PAD src0_sel:WORD_1 src1_sel:DWORD
    v_add_u32_sdwa v34, v21, v74 dst_sel:DWORD dst_unused:UNUSED_PAD src0_sel:WORD_0 src1_sel:DWORD
    v_add_u32_sdwa v35, v21, v74 dst_sel:DWORD dst_unused:UNUSED_PAD src0_sel:WORD_1 src1_sel:DWORD
    v_add_u32_sdwa v36, v22, v74 dst_sel:DWORD dst_unused:UNUSED_PAD src0_sel:WORD_0 src1_sel:DWORD
    v_add_u32_sdwa v37, v22, v74 dst_sel:DWORD dst_unused:UNUSED_PAD src0_sel:WORD_1 src1_sel:DWORD
    v_add_u32_sdwa v38, v23, v74 dst_sel:DWORD dst_unused:UNUSED_PAD src0_sel:WORD_0 src1_sel:DWORD
    v_add_u32_sdwa v39, v23, v74 dst_sel:DWORD dst_unused:UNUSED_PAD src0_sel:WORD_1 src1_sel:DWORD
    v_add_u32_sdwa v40, v24, v74 dst_sel:DWORD dst_unused:UNUSED_PAD src0_sel:WORD_0 src1_sel:DWORD
    v_add_u32_sdwa v41, v24, v74 dst_sel:DWORD dst_unused:UNUSED_PAD src0_sel:WORD_1 src1_sel:DWORD
    buffer_load_dwordx4 v[156:159], v4, s[44:47], s76 offen offset:3072 sc1
    v_add_u32_sdwa v42, v25, v74 dst_sel:DWORD dst_unused:UNUSED_PAD src0_sel:WORD_0 src1_sel:DWORD
    v_add_u32_sdwa v43, v25, v74 dst_sel:DWORD dst_unused:UNUSED_PAD src0_sel:WORD_1 src1_sel:DWORD
    v_add_u32_sdwa v44, v26, v74 dst_sel:DWORD dst_unused:UNUSED_PAD src0_sel:WORD_0 src1_sel:DWORD
    v_add_u32_sdwa v45, v26, v74 dst_sel:DWORD dst_unused:UNUSED_PAD src0_sel:WORD_1 src1_sel:DWORD
    v_add_u32_sdwa v46, v27, v74 dst_sel:DWORD dst_unused:UNUSED_PAD src0_sel:WORD_0 src1_sel:DWORD
    v_add_u32_sdwa v47, v27, v74 dst_sel:DWORD dst_unused:UNUSED_PAD src0_sel:WORD_1 src1_sel:DWORD
    v_add_u32_sdwa v48, v28, v74 dst_sel:DWORD dst_unused:UNUSED_PAD src0_sel:WORD_0 src1_sel:DWORD
    v_add_u32_sdwa v49, v28, v74 dst_sel:DWORD dst_unused:UNUSED_PAD src0_sel:WORD_1 src1_sel:DWORD
    v_add_u32_sdwa v50, v29, v74 dst_sel:DWORD dst_unused:UNUSED_PAD src0_sel:WORD_0 src1_sel:DWORD
    ds_read2st64_b32 v[88:89], v32 offset1:13
    buffer_load_dwordx4 v[160:163], v4, s[44:47], s77 offen offset:0 sc1
    ds_read2st64_b32 v[90:91], v33 offset1:13
    ds_read2st64_b32 v[92:93], v34 offset1:13
    ds_read2st64_b32 v[94:95], v35 offset1:13
    ds_read2st64_b32 v[96:97], v36 offset1:13
    ds_read2st64_b32 v[98:99], v37 offset1:13
    ds_read2st64_b32 v[100:101], v38 offset1:13
    ds_read2st64_b32 v[102:103], v39 offset1:13
    ds_read2st64_b32 v[104:105], v40 offset1:13
    ds_read2st64_b32 v[106:107], v41 offset1:13
    ds_read2st64_b32 v[108:109], v42 offset1:13
    buffer_load_dwordx4 v[164:167], v4, s[44:47], s77 offen offset:1024 sc1
    ds_read2st64_b32 v[110:111], v43 offset1:13
    ds_read2st64_b32 v[112:113], v44 offset1:13
    ds_read2st64_b32 v[114:115], v45 offset1:13
    ds_read2st64_b32 v[116:117], v46 offset1:13
    ds_read2st64_b32 v[118:119], v47 offset1:13
    ds_read2st64_b32 v[120:121], v48 offset1:13
    ds_read2st64_b32 v[122:123], v49 offset1:13
    ds_read2st64_b32 v[124:125], v50 offset1:13
    s_waitcnt lgkmcnt(0)
    v_add_f32 v32, v88, v89
    v_add_f32 v33, v90, v91
    buffer_load_dwordx4 v[168:171], v4, s[44:47], s77 offen offset:2048 sc1
    v_add_f32 v34, v92, v93
    v_add_f32 v35, v94, v95
    v_add_f32 v36, v96, v97
    v_add_f32 v37, v98, v99
    v_add_f32 v38, v100, v101
    v_add_f32 v39, v102, v103
    v_add_f32 v40, v104, v105
    v_add_f32 v41, v106, v107
    v_add_f32 v42, v108, v109
    v_add_f32 v43, v110, v111
    buffer_load_dwordx4 v[172:175], v4, s[44:47], s77 offen offset:3072 sc1
    v_add_f32 v44, v112, v113
    v_add_f32 v45, v114, v115
    v_add_f32 v46, v116, v117
    v_add_f32 v47, v118, v119
    v_add_f32 v48, v120, v121
    v_add_f32 v49, v122, v123
    v_add_f32 v50, v124, v125
    v_cvt_pk_bf16_f32 v96, v32, v33
    v_cvt_pk_bf16_f32 v97, v34, v35
    v_cvt_pk_bf16_f32 v98, v36, v37
    buffer_load_dwordx4 v[176:179], v4, s[44:47], s78 offen offset:0 sc1
    v_cvt_pk_bf16_f32 v99, v38, v39
    v_cvt_pk_bf16_f32 v100, v40, v41
    v_cvt_pk_bf16_f32 v101, v42, v43
    v_cvt_pk_bf16_f32 v102, v44, v45
    v_cvt_pk_bf16_f32 v103, v46, v47
    v_cvt_pk_bf16_f32 v104, v33, v34
    v_cvt_pk_bf16_f32 v105, v35, v36
    v_cvt_pk_bf16_f32 v106, v37, v38
    v_cvt_pk_bf16_f32 v107, v39, v40
    v_cvt_pk_bf16_f32 v108, v41, v42
    buffer_load_dwordx4 v[180:183], v4, s[44:47], s78 offen offset:1024 sc1
    v_cvt_pk_bf16_f32 v109, v43, v44
    v_cvt_pk_bf16_f32 v110, v45, v46
    v_cvt_pk_bf16_f32 v111, v47, v48
    v_cvt_pk_bf16_f32 v112, v34, v35
    v_cvt_pk_bf16_f32 v113, v36, v37
    v_cvt_pk_bf16_f32 v114, v38, v39
    v_cvt_pk_bf16_f32 v115, v40, v41
    v_cvt_pk_bf16_f32 v116, v42, v43
    v_cvt_pk_bf16_f32 v117, v44, v45
    v_cvt_pk_bf16_f32 v118, v46, v47
    buffer_load_dwordx4 v[184:187], v4, s[44:47], s78 offen offset:2048 sc1
    v_cvt_pk_bf16_f32 v119, v48, v49
    v_cvt_pk_bf16_f32 v120, v35, v36
    v_cvt_pk_bf16_f32 v121, v37, v38
    v_cvt_pk_bf16_f32 v122, v39, v40
    v_cvt_pk_bf16_f32 v123, v41, v42
    v_cvt_pk_bf16_f32 v124, v43, v44
    v_cvt_pk_bf16_f32 v125, v45, v46
    v_cvt_pk_bf16_f32 v126, v47, v48
    v_cvt_pk_bf16_f32 v127, v49, v50
    buffer_load_dwordx4 v[188:191], v4, s[44:47], s78 offen offset:3072 sc1
    buffer_load_dwordx4 v[192:195], v4, s[44:47], s79 offen offset:0 sc1
    buffer_load_dwordx4 v[196:199], v4, s[44:47], s79 offen offset:1024 sc1
    buffer_load_dwordx4 v[200:203], v4, s[44:47], s79 offen offset:2048 sc1
    buffer_load_dwordx4 v[204:207], v4, s[44:47], s79 offen offset:3072 sc1
    buffer_load_dwordx4 v[208:211], v4, s[44:47], s80 offen offset:0 sc1
    buffer_load_dwordx4 v[212:215], v4, s[44:47], s80 offen offset:1024 sc1
    buffer_load_dwordx4 v[216:219], v4, s[44:47], s80 offen offset:2048 sc1
    buffer_load_dwordx4 v[220:223], v4, s[44:47], s80 offen offset:3072 sc1
    buffer_load_dwordx4 v[224:227], v4, s[44:47], s81 offen offset:0 sc1
    buffer_load_dwordx4 v[228:231], v4, s[44:47], s81 offen offset:1024 sc1
    buffer_load_dwordx4 v[232:235], v4, s[44:47], s81 offen offset:2048 sc1
    buffer_load_dwordx4 v[236:239], v4, s[44:47], s81 offen offset:3072 sc1
    buffer_load_dwordx4 v[240:243], v4, s[44:47], s82 offen offset:0 sc1
    buffer_load_dwordx4 v[244:247], v4, s[44:47], s82 offen offset:1024 sc1
    buffer_load_dwordx4 v[248:251], v4, s[44:47], s82 offen offset:2048 sc1
    buffer_load_dwordx4 v[252:255], v4, s[44:47], s82 offen offset:3072 sc1
    s_and_b32 s70, s66, 1
    s_mul_i32 s70, s70, 229376
    s_sub_u32 s70, s70, 114688
    v_add_u32 v59, s70, v4
    s_mul_i32 s69, s94, 0
    ds_read_b128 v[64:67], v11 offset:0
    s_waitcnt lgkmcnt(0)
    v_min_u32 v64, v64, v65
    v_min3_u32 v64, v64, v66, v67
    v_cmp_gt_u32 vcc, 7, v64
    s_nop 4
    s_cbranch_vccnz Lretry21
Ldone21:
    v_mov_b32 v10, 10
    ds_write_b128 v16, v[96:99] offset:0
    ds_write_b128 v16, v[100:103] offset:16
    ds_write_b128 v16, v[104:107] offset:4160
    ds_write_b128 v16, v[108:111] offset:4176
    ds_write_b128 v16, v[112:115] offset:8320
    ds_write_b128 v16, v[116:119] offset:8336
    ds_write_b128 v16, v[120:123] offset:12480
    ds_write_b128 v16, v[124:127] offset:12496
    ds_write_b128 v57, v[52:55]
    ds_write_b128 v58, v[52:55]
    s_waitcnt vmcnt(29)
    ds_write_b128 v31, v[128:131]
    s_waitcnt vmcnt(28)
    ds_write_b128 v31, v[132:135] offset:2048
    ds_write_b32 v8, v10
    s_setprio 1
    ds_read_b128 v[64:67], v11 offset:16
    s_waitcnt lgkmcnt(0)
    v_min_u32 v64, v64, v65
    v_min3_u32 v64, v64, v66, v67
    v_cmp_gt_u32 vcc, 10, v64
    s_nop 4
    s_cbranch_vccnz Lretry22
Ldone22:
    s_lshl_b32 s71, s62, 1
    s_add_u32 s71, s71, s19
    s_mul_i32 s72, s71, 4352
    s_add_u32 s32, s72, 5242880
    s_lshr_b32 s72, s71, 6
    s_lshl_b32 s72, s72, 3
    s_lshr_b32 s73, s95, 6
    s_add_u32 s72, s72, s73
    s_bfe_u32 s73, s71, 0x20003
    s_add_u32 s72, s72, s73
    s_lshl_b32 s72, s72, 7
    s_add_u32 s33, s72, 802816
    s_bitcmp1_b32 s94, 0
    s_cbranch_scc1 Lconv1
    ds_read_b64 v[112:113], v136 offset:4032
    ds_read_b64 v[114:115], v136 offset:4040
    ds_read_b128 v[48:51], v137 offset:192
    ds_read_b128 v[52:55], v137 offset:704
    ds_read_b128 v[56:59], v137 offset:1216
    ds_read_b128 v[60:63], v137 offset:1728
    ds_read_b128 v[64:67], v137 offset:2240
    ds_read_b128 v[68:71], v137 offset:2752
    ds_read_b128 v[72:75], v137 offset:3264
    ds_read_b128 v[76:79], v137 offset:3776
    ds_read_b64 v[116:117], v136 offset:3520
    ds_read_b64 v[118:119], v136 offset:3528
    ds_read_b64 v[120:121], v136 offset:3008
    ds_read_b64 v[122:123], v136 offset:3016
    s_mul_i32 s72, s19, 4576
    s_add_u32 s72, s72, 132064
    v_mul_u32_u24 v141, 1536, v142
    v_add_u32 v141, v141, v138
    v_add_u32 v143, s72, v141
    v_xor_b32 v12, 4, v8
    s_setprio 0
    ds_read_b128 v[132:135], v11 offset:0
    s_waitcnt lgkmcnt(0)
    v_min_u32 v132, v132, v133
    v_min3_u32 v132, v132, v134, v135
    v_cmp_gt_u32 vcc, 9, v132
    s_nop 4
    s_cbranch_vccnz Lretry23
Ldone23:
    v_mfma_f32_16x16x32_bf16 v[16:19], v[112:115], v[48:51], 0
    ds_read_b128 v[80:83], v137 offset:128
    v_mfma_f32_16x16x32_bf16 v[32:35], v[112:115], v[52:55], 0
    ds_read_b128 v[84:87], v137 offset:640
    v_mfma_f32_16x16x32_bf16 v[36:39], v[112:115], v[56:59], 0
    ds_read_b128 v[88:91], v137 offset:1152
    v_mfma_f32_16x16x32_bf16 v[20:23], v[112:115], v[60:63], 0
    ds_read_b128 v[92:95], v137 offset:1664
    v_mfma_f32_16x16x32_bf16 v[24:27], v[112:115], v[64:67], 0
    ds_read_b128 v[96:99], v137 offset:2176
    v_mfma_f32_16x16x32_bf16 v[40:43], v[112:115], v[68:71], 0
    ds_read_b64 v[124:125], v136 offset:2496
    v_mfma_f32_16x16x32_bf16 v[44:47], v[112:115], v[72:75], 0
    ds_read_b64 v[126:127], v136 offset:2504
    v_mfma_f32_16x16x32_bf16 v[28:31], v[112:115], v[76:79], 0
    ds_read_b128 v[100:103], v137 offset:2688
    v_mfma_f32_16x16x32_bf16 v[32:35], v[116:119], v[48:51], v[32:35]
    ds_read_b128 v[104:107], v137 offset:3200
    v_mfma_f32_16x16x32_bf16 v[36:39], v[116:119], v[52:55], v[36:39]
    ds_read_b128 v[108:111], v137 offset:3712
    v_mfma_f32_16x16x32_bf16 v[20:23], v[116:119], v[56:59], v[20:23]
    ds_read_b64 v[128:129], v136 offset:1984
    v_mfma_f32_16x16x32_bf16 v[24:27], v[116:119], v[60:63], v[24:27]
    ds_read_b64 v[130:131], v136 offset:1992
    v_mfma_f32_16x16x32_bf16 v[40:43], v[116:119], v[64:67], v[40:43]
    ds_read_b64 v[132:133], v136 offset:1472
    v_mfma_f32_16x16x32_bf16 v[44:47], v[116:119], v[68:71], v[44:47]
    ds_read_b64 v[134:135], v136 offset:1480
    v_mfma_f32_16x16x32_bf16 v[28:31], v[116:119], v[72:75], v[28:31]
    ds_read_b64 v[112:113], v136 offset:960
    v_mfma_f32_16x16x32_bf16 v[36:39], v[120:123], v[48:51], v[36:39]
    ds_read_b64 v[114:115], v136 offset:968
    v_mfma_f32_16x16x32_bf16 v[20:23], v[120:123], v[52:55], v[20:23]
    ds_read_b64 v[116:117], v136 offset:448
    v_mfma_f32_16x16x32_bf16 v[24:27], v[120:123], v[56:59], v[24:27]
    ds_read_b64 v[118:119], v136 offset:456
    v_mfma_f32_16x16x32_bf16 v[40:43], v[120:123], v[60:63], v[40:43]
    v_mfma_f32_16x16x32_bf16 v[44:47], v[120:123], v[64:67], v[44:47]
    v_mfma_f32_16x16x32_bf16 v[28:31], v[120:123], v[68:71], v[28:31]
    ds_read_b64 v[120:121], v136 offset:3968
    s_waitcnt lgkmcnt(12)
    v_mfma_f32_16x16x32_bf16 v[20:23], v[124:127], v[48:51], v[20:23]
    ds_read_b64 v[122:123], v136 offset:3976
    v_mfma_f32_16x16x32_bf16 v[24:27], v[124:127], v[52:55], v[24:27]
    v_mfma_f32_16x16x32_bf16 v[40:43], v[124:127], v[56:59], v[40:43]
    v_mfma_f32_16x16x32_bf16 v[44:47], v[124:127], v[60:63], v[44:47]
    v_mfma_f32_16x16x32_bf16 v[28:31], v[124:127], v[64:67], v[28:31]
    ds_read_b64 v[124:125], v136 offset:3456
    s_waitcnt lgkmcnt(9)
    v_mfma_f32_16x16x32_bf16 v[24:27], v[128:131], v[48:51], v[24:27]
    ds_read_b64 v[126:127], v136 offset:3464
    v_mfma_f32_16x16x32_bf16 v[40:43], v[128:131], v[52:55], v[40:43]
    v_mfma_f32_16x16x32_bf16 v[44:47], v[128:131], v[56:59], v[44:47]
    v_mfma_f32_16x16x32_bf16 v[28:31], v[128:131], v[60:63], v[28:31]
    ds_read_b64 v[128:129], v136 offset:2944
    s_waitcnt lgkmcnt(9)
    v_mfma_f32_16x16x32_bf16 v[40:43], v[132:135], v[48:51], v[40:43]
    ds_read_b64 v[130:131], v136 offset:2952
    v_mov_b32 v10, 11
    ds_write_b32 v8, v10
    v_mfma_f32_16x16x32_bf16 v[44:47], v[132:135], v[52:55], v[44:47]
    v_mfma_f32_16x16x32_bf16 v[28:31], v[132:135], v[56:59], v[28:31]
    s_waitcnt lgkmcnt(9)
    v_mfma_f32_16x16x32_bf16 v[44:47], v[112:115], v[48:51], v[44:47]
    v_mfma_f32_16x16x32_bf16 v[28:31], v[112:115], v[52:55], v[28:31]
    s_waitcnt lgkmcnt(7)
    v_mfma_f32_16x16x32_bf16 v[28:31], v[116:119], v[48:51], v[28:31]
    ds_read_b128 v[48:51], v137 offset:64
    s_waitcnt lgkmcnt(6)
    v_mfma_f32_16x16x32_bf16 v[16:19], v[120:123], v[80:83], v[16:19]
    ds_read_b128 v[52:55], v137 offset:576
    v_mfma_f32_16x16x32_bf16 v[32:35], v[120:123], v[84:87], v[32:35]
    ds_read_b128 v[56:59], v137 offset:1088
    v_mfma_f32_16x16x32_bf16 v[36:39], v[120:123], v[88:91], v[36:39]
    ds_read_b128 v[60:63], v137 offset:1600
    v_mfma_f32_16x16x32_bf16 v[20:23], v[120:123], v[92:95], v[20:23]
    ds_read_b128 v[64:67], v137 offset:2112
    v_mfma_f32_16x16x32_bf16 v[24:27], v[120:123], v[96:99], v[24:27]
    ds_read_b64 v[132:133], v136 offset:2432
    v_mfma_f32_16x16x32_bf16 v[40:43], v[120:123], v[100:103], v[40:43]
    ds_read_b64 v[134:135], v136 offset:2440
    v_mfma_f32_16x16x32_bf16 v[44:47], v[120:123], v[104:107], v[44:47]
    ds_read_b128 v[68:71], v137 offset:2624
    v_mfma_f32_16x16x32_bf16 v[28:31], v[120:123], v[108:111], v[28:31]
    ds_read_b128 v[72:75], v137 offset:3136
    s_waitcnt lgkmcnt(12)
    v_mfma_f32_16x16x32_bf16 v[32:35], v[124:127], v[80:83], v[32:35]
    ds_read_b128 v[76:79], v137 offset:3648
    v_mfma_f32_16x16x32_bf16 v[36:39], v[124:127], v[84:87], v[36:39]
    ds_read_b64 v[112:113], v136 offset:1920
    v_mfma_f32_16x16x32_bf16 v[20:23], v[124:127], v[88:91], v[20:23]
    ds_read_b64 v[114:115], v136 offset:1928
    v_mfma_f32_16x16x32_bf16 v[24:27], v[124:127], v[92:95], v[24:27]
    ds_read_b64 v[116:117], v136 offset:1408
    v_mfma_f32_16x16x32_bf16 v[40:43], v[124:127], v[96:99], v[40:43]
    ds_read_b64 v[118:119], v136 offset:1416
    v_mfma_f32_16x16x32_bf16 v[44:47], v[124:127], v[100:103], v[44:47]
    ds_read_b64 v[120:121], v136 offset:896
    v_mfma_f32_16x16x32_bf16 v[28:31], v[124:127], v[104:107], v[28:31]
    ds_read_b64 v[122:123], v136 offset:904
    s_waitcnt lgkmcnt(15)
    v_mfma_f32_16x16x32_bf16 v[36:39], v[128:131], v[80:83], v[36:39]
    ds_read_b64 v[124:125], v136 offset:384
    v_mfma_f32_16x16x32_bf16 v[20:23], v[128:131], v[84:87], v[20:23]
    ds_read_b64 v[126:127], v136 offset:392
    v_mfma_f32_16x16x32_bf16 v[24:27], v[128:131], v[88:91], v[24:27]
    v_mfma_f32_16x16x32_bf16 v[40:43], v[128:131], v[92:95], v[40:43]
    v_mfma_f32_16x16x32_bf16 v[44:47], v[128:131], v[96:99], v[44:47]
    v_mfma_f32_16x16x32_bf16 v[28:31], v[128:131], v[100:103], v[28:31]
    ds_read_b64 v[128:129], v136 offset:3904
    s_waitcnt lgkmcnt(12)
    v_mfma_f32_16x16x32_bf16 v[20:23], v[132:135], v[80:83], v[20:23]
    ds_read_b64 v[130:131], v136 offset:3912
    v_mfma_f32_16x16x32_bf16 v[24:27], v[132:135], v[84:87], v[24:27]
    v_mfma_f32_16x16x32_bf16 v[40:43], v[132:135], v[88:91], v[40:43]
    v_mfma_f32_16x16x32_bf16 v[44:47], v[132:135], v[92:95], v[44:47]
    v_mfma_f32_16x16x32_bf16 v[28:31], v[132:135], v[96:99], v[28:31]
    ds_read_b64 v[132:133], v136 offset:3392
    s_waitcnt lgkmcnt(9)
    v_mfma_f32_16x16x32_bf16 v[24:27], v[112:115], v[80:83], v[24:27]
    ds_read_b64 v[134:135], v136 offset:3400
    v_mfma_f32_16x16x32_bf16 v[40:43], v[112:115], v[84:87], v[40:43]
    v_mfma_f32_16x16x32_bf16 v[44:47], v[112:115], v[88:91], v[44:47]
    v_mfma_f32_16x16x32_bf16 v[28:31], v[112:115], v[92:95], v[28:31]
    ds_read_b64 v[112:113], v136 offset:2880
    s_waitcnt lgkmcnt(9)
    v_mfma_f32_16x16x32_bf16 v[40:43], v[116:119], v[80:83], v[40:43]
    ds_read_b64 v[114:115], v136 offset:2888
    v_mfma_f32_16x16x32_bf16 v[44:47], v[116:119], v[84:87], v[44:47]
    v_mfma_f32_16x16x32_bf16 v[28:31], v[116:119], v[88:91], v[28:31]
    s_waitcnt lgkmcnt(8)
    v_mfma_f32_16x16x32_bf16 v[44:47], v[120:123], v[80:83], v[44:47]
    v_mfma_f32_16x16x32_bf16 v[28:31], v[120:123], v[84:87], v[28:31]
    ds_read_b128 v[84:87], v137 offset:512
    s_waitcnt lgkmcnt(7)
    v_mfma_f32_16x16x32_bf16 v[28:31], v[124:127], v[80:83], v[28:31]
    ds_read_b128 v[88:91], v137 offset:1024
    s_waitcnt lgkmcnt(6)
    v_mfma_f32_16x16x32_bf16 v[16:19], v[128:131], v[48:51], v[16:19]
    ds_read_b128 v[100:103], v137 offset:2560
    v_mfma_f32_16x16x32_bf16 v[32:35], v[128:131], v[52:55], v[32:35]
    ds_read_b128 v[104:107], v137 offset:3072
    v_mfma_f32_16x16x32_bf16 v[36:39], v[128:131], v[56:59], v[36:39]
    ds_read_b128 v[80:83], v137 offset:0
    v_mfma_f32_16x16x32_bf16 v[20:23], v[128:131], v[60:63], v[20:23]
    ds_read_b64 v[116:117], v136 offset:2368
    v_mfma_f32_16x16x32_bf16 v[24:27], v[128:131], v[64:67], v[24:27]
    ds_read_b64 v[118:119], v136 offset:2376
    v_mfma_f32_16x16x32_bf16 v[40:43], v[128:131], v[68:71], v[40:43]
    ds_read_b128 v[96:99], v137 offset:2048
    v_mfma_f32_16x16x32_bf16 v[44:47], v[128:131], v[72:75], v[44:47]
    ds_read_b128 v[92:95], v137 offset:1536
    v_mfma_f32_16x16x32_bf16 v[28:31], v[128:131], v[76:79], v[28:31]
    ds_read_b64 v[120:121], v136 offset:1856
    s_waitcnt lgkmcnt(12)
    v_mfma_f32_16x16x32_bf16 v[32:35], v[132:135], v[48:51], v[32:35]
    ds_read_b64 v[122:123], v136 offset:1864
    v_mfma_f32_16x16x32_bf16 v[36:39], v[132:135], v[52:55], v[36:39]
    ds_read_b64 v[124:125], v136 offset:1344
    v_mfma_f32_16x16x32_bf16 v[20:23], v[132:135], v[56:59], v[20:23]
    ds_read_b64 v[126:127], v136 offset:1352
    v_mfma_f32_16x16x32_bf16 v[24:27], v[132:135], v[60:63], v[24:27]
    ds_read_b64 v[128:129], v136 offset:832
    v_mfma_f32_16x16x32_bf16 v[40:43], v[132:135], v[64:67], v[40:43]
    ds_read_b64 v[130:131], v136 offset:840
    v_mfma_f32_16x16x32_bf16 v[44:47], v[132:135], v[68:71], v[44:47]
    v_mfma_f32_16x16x32_bf16 v[28:31], v[132:135], v[72:75], v[28:31]
    ds_read_b64 v[132:133], v136 offset:320
    s_waitcnt lgkmcnt(15)
    v_mfma_f32_16x16x32_bf16 v[36:39], v[112:115], v[48:51], v[36:39]
    ds_read_b64 v[134:135], v136 offset:328
    v_mfma_f32_16x16x32_bf16 v[20:23], v[112:115], v[52:55], v[20:23]
    v_mfma_f32_16x16x32_bf16 v[24:27], v[112:115], v[56:59], v[24:27]
    v_mfma_f32_16x16x32_bf16 v[40:43], v[112:115], v[60:63], v[40:43]
    v_mfma_f32_16x16x32_bf16 v[44:47], v[112:115], v[64:67], v[44:47]
    v_mfma_f32_16x16x32_bf16 v[28:31], v[112:115], v[68:71], v[28:31]
    ds_read_b64 v[112:113], v136 offset:3840
    s_waitcnt lgkmcnt(11)
    v_mfma_f32_16x16x32_bf16 v[20:23], v[116:119], v[48:51], v[20:23]
    ds_read_b64 v[114:115], v136 offset:3848
    v_mfma_f32_16x16x32_bf16 v[24:27], v[116:119], v[52:55], v[24:27]
    ds_read_b128 v[108:111], v137 offset:3584
    v_mfma_f32_16x16x32_bf16 v[40:43], v[116:119], v[56:59], v[40:43]
    v_mfma_f32_16x16x32_bf16 v[44:47], v[116:119], v[60:63], v[44:47]
    v_mfma_f32_16x16x32_bf16 v[28:31], v[116:119], v[64:67], v[28:31]
    ds_read_b64 v[116:117], v136 offset:3328
    s_waitcnt lgkmcnt(10)
    v_mfma_f32_16x16x32_bf16 v[24:27], v[120:123], v[48:51], v[24:27]
    ds_read_b64 v[118:119], v136 offset:3336
    v_mfma_f32_16x16x32_bf16 v[40:43], v[120:123], v[52:55], v[40:43]
    v_mfma_f32_16x16x32_bf16 v[44:47], v[120:123], v[56:59], v[44:47]
    v_mov_b32 v10, 12
    v_mfma_f32_16x16x32_bf16 v[28:31], v[120:123], v[60:63], v[28:31]
    ds_read_b64 v[120:121], v136 offset:2816
    s_waitcnt lgkmcnt(10)
    v_mfma_f32_16x16x32_bf16 v[40:43], v[124:127], v[48:51], v[40:43]
    ds_read_b64 v[122:123], v136 offset:2824
    v_mfma_f32_16x16x32_bf16 v[44:47], v[124:127], v[52:55], v[44:47]
    v_mfma_f32_16x16x32_bf16 v[28:31], v[124:127], v[56:59], v[28:31]
    ds_read_b64 v[124:125], v136 offset:2304
    ds_read_b64 v[126:127], v136 offset:2312
    s_waitcnt lgkmcnt(11)
    v_mfma_f32_16x16x32_bf16 v[44:47], v[128:131], v[48:51], v[44:47]
    v_mfma_f32_16x16x32_bf16 v[28:31], v[128:131], v[52:55], v[28:31]
    ds_read_b64 v[128:129], v136 offset:1792
    ds_read_b64 v[130:131], v136 offset:1800
    s_waitcnt lgkmcnt(11)
    v_mfma_f32_16x16x32_bf16 v[28:31], v[132:135], v[48:51], v[28:31]
    ds_read_b64 v[132:133], v136 offset:1280
    ds_read_b64 v[134:135], v136 offset:1288
    s_waitcnt lgkmcnt(11)
    v_mfma_f32_16x16x32_bf16 v[32:35], v[112:115], v[84:87], v[32:35]
    v_mfma_f32_16x16x32_bf16 v[36:39], v[112:115], v[88:91], v[36:39]
    v_mfma_f32_16x16x32_bf16 v[40:43], v[112:115], v[100:103], v[40:43]
    ds_read_b128 v[48:51], v143 offset:0
    ds_read_b128 v[52:55], v143 offset:2048
    v_mfma_f32_16x16x32_bf16 v[44:47], v[112:115], v[104:107], v[44:47]
    ds_read_b64 v[112:113], v136 offset:768
    ds_read_b64 v[114:115], v136 offset:776
    s_waitcnt lgkmcnt(12)
    v_mfma_f32_16x16x32_bf16 v[32:35], v[116:119], v[80:83], v[32:35]
    v_mfma_f32_16x16x32_bf16 v[36:39], v[116:119], v[84:87], v[36:39]
    v_mfma_f32_16x16x32_bf16 v[40:43], v[116:119], v[96:99], v[40:43]
    v_mfma_f32_16x16x32_bf16 v[44:47], v[116:119], v[100:103], v[44:47]
    ds_read_b64 v[116:117], v136 offset:3840
    ds_read_b64 v[118:119], v136 offset:3848
    s_waitcnt lgkmcnt(12)
    v_mfma_f32_16x16x32_bf16 v[36:39], v[120:123], v[80:83], v[36:39]
    s_nop 0
    ds_write_b128 v139, v[32:35] offset:0
    v_mfma_f32_16x16x32_bf16 v[40:43], v[120:123], v[92:95], v[40:43]
    v_mfma_f32_16x16x32_bf16 v[44:47], v[120:123], v[96:99], v[44:47]
    ds_read_b64 v[120:121], v136 offset:3328
    ds_read_b64 v[122:123], v136 offset:3336
    s_waitcnt lgkmcnt(13)
    v_mfma_f32_16x16x32_bf16 v[40:43], v[124:127], v[88:91], v[40:43]
    v_mfma_f32_16x16x32_bf16 v[44:47], v[124:127], v[92:95], v[44:47]
    ds_read_b64 v[124:125], v136 offset:2816
    ds_read_b64 v[126:127], v136 offset:2824
    ds_write_b128 v139, v[36:39] offset:1024
    s_waitcnt lgkmcnt(14)
    v_mfma_f32_16x16x32_bf16 v[40:43], v[128:131], v[84:87], v[40:43]
    v_mfma_f32_16x16x32_bf16 v[44:47], v[128:131], v[88:91], v[44:47]
    ds_read_b64 v[128:129], v136 offset:2304
    ds_read_b64 v[130:131], v136 offset:2312
    s_waitcnt lgkmcnt(14)
    v_mfma_f32_16x16x32_bf16 v[40:43], v[132:135], v[80:83], v[40:43]
    v_mfma_f32_16x16x32_bf16 v[44:47], v[132:135], v[84:87], v[44:47]
    ds_read_b64 v[132:133], v136 offset:1792
    ds_read_b64 v[134:135], v136 offset:1800
    s_waitcnt lgkmcnt(14)
    v_lshlrev_b32 v56, 16, v48
    s_waitcnt lgkmcnt(12)
    v_mfma_f32_16x16x32_bf16 v[44:47], v[112:115], v[80:83], v[44:47]
    ds_read_b64 v[112:113], v136 offset:1280
    ds_read_b64 v[114:115], v136 offset:1288
    v_and_b32 v57, 0xffff0000, v48
    s_waitcnt lgkmcnt(12)
    v_mfma_f32_16x16x32_bf16 v[16:19], v[116:119], v[80:83], v[16:19]
    v_lshlrev_b32 v58, 16, v49
    v_mfma_f32_16x16x32_bf16 v[20:23], v[116:119], v[92:95], v[20:23]
    ds_write_b128 v139, v[40:43] offset:2048
    v_and_b32 v59, 0xffff0000, v49
    v_mfma_f32_16x16x32_bf16 v[24:27], v[116:119], v[96:99], v[24:27]
    v_lshlrev_b32 v60, 16, v50
    v_mfma_f32_16x16x32_bf16 v[28:31], v[116:119], v[108:111], v[28:31]
    ds_read_b64 v[116:117], v136 offset:768
    ds_read_b64 v[118:119], v136 offset:776
    ds_write_b128 v139, v[44:47] offset:3072
    ds_write_b32 v8, v10
    v_and_b32 v61, 0xffff0000, v50
    s_waitcnt lgkmcnt(14)
    v_mfma_f32_16x16x32_bf16 v[20:23], v[120:123], v[88:91], v[20:23]
    v_lshlrev_b32 v62, 16, v51
    v_mfma_f32_16x16x32_bf16 v[24:27], v[120:123], v[92:95], v[24:27]
    v_and_b32 v63, 0xffff0000, v51
    v_mfma_f32_16x16x32_bf16 v[28:31], v[120:123], v[104:107], v[28:31]
    ds_read_b64 v[120:121], v136 offset:256
    ds_read_b64 v[122:123], v136 offset:264
    v_lshlrev_b32 v64, 16, v52
    s_waitcnt lgkmcnt(14)
    v_mfma_f32_16x16x32_bf16 v[20:23], v[124:127], v[84:87], v[20:23]
    v_and_b32 v65, 0xffff0000, v52
    v_mfma_f32_16x16x32_bf16 v[24:27], v[124:127], v[88:91], v[24:27]
    v_lshlrev_b32 v66, 16, v53
    v_mfma_f32_16x16x32_bf16 v[28:31], v[124:127], v[100:103], v[28:31]
    v_and_b32 v67, 0xffff0000, v53
    s_waitcnt lgkmcnt(11)
    v_mfma_f32_16x16x32_bf16 v[20:23], v[128:131], v[80:83], v[20:23]
    v_lshlrev_b32 v68, 16, v54
    v_mfma_f32_16x16x32_bf16 v[24:27], v[128:131], v[84:87], v[24:27]
    v_and_b32 v69, 0xffff0000, v54
    v_mfma_f32_16x16x32_bf16 v[28:31], v[128:131], v[96:99], v[28:31]
    v_lshlrev_b32 v70, 16, v55
    s_waitcnt lgkmcnt(9)
    v_mfma_f32_16x16x32_bf16 v[24:27], v[132:135], v[80:83], v[24:27]
    v_and_b32 v71, 0xffff0000, v55
    ds_read_b32 v72, v12
    v_mfma_f32_16x16x32_bf16 v[28:31], v[132:135], v[92:95], v[28:31]
    s_waitcnt lgkmcnt(8)
    v_mfma_f32_16x16x32_bf16 v[28:31], v[112:115], v[88:91], v[28:31]
    s_waitcnt lgkmcnt(5)
    v_mfma_f32_16x16x32_bf16 v[28:31], v[116:119], v[84:87], v[28:31]
    s_waitcnt lgkmcnt(1)
    v_mfma_f32_16x16x32_bf16 v[28:31], v[120:123], v[80:83], v[28:31]
    s_waitcnt lgkmcnt(0)
    v_cmp_gt_u32 vcc, 12, v72
    s_nop 4
    s_cbranch_vccnz Lretry24
Ldone24:
    ds_read_b128 v[32:35], v140 offset:0
    ds_read_b128 v[36:39], v140 offset:1024
    ds_read_b128 v[40:43], v140 offset:2048
    ds_read_b128 v[44:47], v140 offset:3072
    v_mov_b32 v10, 13
    ds_write_b32 v8, v10
    s_waitcnt lgkmcnt(1)
    s_load_dword s50, s[30:31], s48 glc
    v_add_f32 v16, v16, v32
    v_add_f32 v17, v17, v33
    v_add_f32 v18, v18, v34
    v_add_f32 v19, v19, v35
    v_add_f32 v20, v20, v36
    v_add_f32 v21, v21, v37
    v_add_f32 v22, v22, v38
    v_add_f32 v23, v23, v39
    v_permlane16_swap_b32 v16, v20
    v_permlane16_swap_b32 v17, v21
    v_permlane16_swap_b32 v18, v22
    v_permlane16_swap_b32 v19, v23
    v_fmac_f32 v16, s93, v56
    v_fmac_f32 v17, s93, v57
    v_fmac_f32 v18, s93, v58
    v_fmac_f32 v19, s93, v59
    v_fmac_f32 v20, s93, v60
    v_fmac_f32 v21, s93, v61
    v_fmac_f32 v22, s93, v62
    v_fmac_f32 v23, s93, v63
    v_cvt_pk_bf16_f32 v48, v16, v17
    v_cvt_pk_bf16_f32 v49, v18, v19
    v_cvt_pk_bf16_f32 v50, v20, v21
    v_cvt_pk_bf16_f32 v51, v22, v23
    v_add_f32 v24, v24, v40
    v_add_f32 v25, v25, v41
    v_add_f32 v26, v26, v42
    v_add_f32 v27, v27, v43
    v_add_f32 v28, v28, v44
    v_add_f32 v29, v29, v45
    v_add_f32 v30, v30, v46
    v_add_f32 v31, v31, v47
    v_permlane16_swap_b32 v24, v28
    v_permlane16_swap_b32 v25, v29
    v_permlane16_swap_b32 v26, v30
    v_permlane16_swap_b32 v27, v31
    v_fmac_f32 v24, s93, v64
    v_fmac_f32 v25, s93, v65
    v_fmac_f32 v26, s93, v66
    v_fmac_f32 v27, s93, v67
    v_fmac_f32 v28, s93, v68
    v_fmac_f32 v29, s93, v69
    v_fmac_f32 v30, s93, v70
    v_fmac_f32 v31, s93, v71
    v_cvt_pk_bf16_f32 v52, v24, v25
    v_cvt_pk_bf16_f32 v53, v26, v27
    v_cvt_pk_bf16_f32 v54, v28, v29
    v_cvt_pk_bf16_f32 v55, v30, v31
    buffer_store_dwordx4 v[48:51], v141, s[44:47], s32 offen offset:0 sc1
    buffer_store_dwordx4 v[52:55], v141, s[44:47], s32 offen offset:2048 sc1
    s_nop 0
    s_branch LYg2
Lconv1:
    ds_read_b64 v[112:113], v136 offset:4032
    ds_read_b64 v[114:115], v136 offset:4040
    ds_read_b128 v[48:51], v137 offset:192
    ds_read_b128 v[52:55], v137 offset:704
    ds_read_b128 v[56:59], v137 offset:1216
    ds_read_b128 v[60:63], v137 offset:1728
    ds_read_b128 v[64:67], v137 offset:2240
    ds_read_b128 v[68:71], v137 offset:2752
    ds_read_b128 v[72:75], v137 offset:3264
    ds_read_b128 v[76:79], v137 offset:3776
    ds_read_b64 v[116:117], v136 offset:3520
    ds_read_b64 v[118:119], v136 offset:3528
    ds_read_b64 v[120:121], v136 offset:3008
    ds_read_b64 v[122:123], v136 offset:3016
    s_mul_i32 s72, s19, 4576
    s_add_u32 s72, s72, 132064
    v_mul_u32_u24 v141, 512, v142
    v_add_u32 v141, v141, v138
    v_add_u32 v143, s72, v141
    v_xor_b32 v12, 4, v8
    s_setprio 0
    ds_read_b128 v[132:135], v11 offset:0
    s_waitcnt lgkmcnt(0)
    v_min_u32 v132, v132, v133
    v_min3_u32 v132, v132, v134, v135
    v_cmp_gt_u32 vcc, 9, v132
    s_nop 4
    s_cbranch_vccnz Lretry25
Ldone25:
    v_mfma_f32_16x16x32_bf16 v[32:35], v[112:115], v[48:51], 0
    ds_read_b128 v[80:83], v137 offset:128
    v_mfma_f32_16x16x32_bf16 v[16:19], v[112:115], v[52:55], 0
    ds_read_b128 v[84:87], v137 offset:640
    v_mfma_f32_16x16x32_bf16 v[20:23], v[112:115], v[56:59], 0
    ds_read_b128 v[88:91], v137 offset:1152
    v_mfma_f32_16x16x32_bf16 v[36:39], v[112:115], v[60:63], 0
    ds_read_b128 v[92:95], v137 offset:1664
    v_mfma_f32_16x16x32_bf16 v[40:43], v[112:115], v[64:67], 0
    ds_read_b128 v[96:99], v137 offset:2176
    v_mfma_f32_16x16x32_bf16 v[24:27], v[112:115], v[68:71], 0
    ds_read_b64 v[124:125], v136 offset:2496
    v_mfma_f32_16x16x32_bf16 v[28:31], v[112:115], v[72:75], 0
    ds_read_b64 v[126:127], v136 offset:2504
    v_mfma_f32_16x16x32_bf16 v[44:47], v[112:115], v[76:79], 0
    ds_read_b128 v[100:103], v137 offset:2688
    v_mfma_f32_16x16x32_bf16 v[16:19], v[116:119], v[48:51], v[16:19]
    ds_read_b128 v[104:107], v137 offset:3200
    v_mfma_f32_16x16x32_bf16 v[20:23], v[116:119], v[52:55], v[20:23]
    ds_read_b128 v[108:111], v137 offset:3712
    v_mfma_f32_16x16x32_bf16 v[36:39], v[116:119], v[56:59], v[36:39]
    ds_read_b64 v[128:129], v136 offset:1984
    v_mfma_f32_16x16x32_bf16 v[40:43], v[116:119], v[60:63], v[40:43]
    ds_read_b64 v[130:131], v136 offset:1992
    v_mfma_f32_16x16x32_bf16 v[24:27], v[116:119], v[64:67], v[24:27]
    ds_read_b64 v[132:133], v136 offset:1472
    v_mfma_f32_16x16x32_bf16 v[28:31], v[116:119], v[68:71], v[28:31]
    ds_read_b64 v[134:135], v136 offset:1480
    v_mfma_f32_16x16x32_bf16 v[44:47], v[116:119], v[72:75], v[44:47]
    ds_read_b64 v[112:113], v136 offset:960
    v_mfma_f32_16x16x32_bf16 v[20:23], v[120:123], v[48:51], v[20:23]
    ds_read_b64 v[114:115], v136 offset:968
    v_mfma_f32_16x16x32_bf16 v[36:39], v[120:123], v[52:55], v[36:39]
    ds_read_b64 v[116:117], v136 offset:448
    v_mfma_f32_16x16x32_bf16 v[40:43], v[120:123], v[56:59], v[40:43]
    ds_read_b64 v[118:119], v136 offset:456
    v_mfma_f32_16x16x32_bf16 v[24:27], v[120:123], v[60:63], v[24:27]
    v_mfma_f32_16x16x32_bf16 v[28:31], v[120:123], v[64:67], v[28:31]
    v_mfma_f32_16x16x32_bf16 v[44:47], v[120:123], v[68:71], v[44:47]
    ds_read_b64 v[120:121], v136 offset:3968
    s_waitcnt lgkmcnt(12)
    v_mfma_f32_16x16x32_bf16 v[36:39], v[124:127], v[48:51], v[36:39]
    ds_read_b64 v[122:123], v136 offset:3976
    v_mfma_f32_16x16x32_bf16 v[40:43], v[124:127], v[52:55], v[40:43]
    v_mfma_f32_16x16x32_bf16 v[24:27], v[124:127], v[56:59], v[24:27]
    v_mfma_f32_16x16x32_bf16 v[28:31], v[124:127], v[60:63], v[28:31]
    v_mfma_f32_16x16x32_bf16 v[44:47], v[124:127], v[64:67], v[44:47]
    ds_read_b64 v[124:125], v136 offset:3456
    s_waitcnt lgkmcnt(9)
    v_mfma_f32_16x16x32_bf16 v[40:43], v[128:131], v[48:51], v[40:43]
    ds_read_b64 v[126:127], v136 offset:3464
    v_mfma_f32_16x16x32_bf16 v[24:27], v[128:131], v[52:55], v[24:27]
    v_mfma_f32_16x16x32_bf16 v[28:31], v[128:131], v[56:59], v[28:31]
    v_mfma_f32_16x16x32_bf16 v[44:47], v[128:131], v[60:63], v[44:47]
    ds_read_b64 v[128:129], v136 offset:2944
    s_waitcnt lgkmcnt(9)
    v_mfma_f32_16x16x32_bf16 v[24:27], v[132:135], v[48:51], v[24:27]
    ds_read_b64 v[130:131], v136 offset:2952
    v_mov_b32 v10, 11
    ds_write_b32 v8, v10
    v_mfma_f32_16x16x32_bf16 v[28:31], v[132:135], v[52:55], v[28:31]
    v_mfma_f32_16x16x32_bf16 v[44:47], v[132:135], v[56:59], v[44:47]
    s_waitcnt lgkmcnt(9)
    v_mfma_f32_16x16x32_bf16 v[28:31], v[112:115], v[48:51], v[28:31]
    v_mfma_f32_16x16x32_bf16 v[44:47], v[112:115], v[52:55], v[44:47]
    s_waitcnt lgkmcnt(7)
    v_mfma_f32_16x16x32_bf16 v[44:47], v[116:119], v[48:51], v[44:47]
    ds_read_b128 v[48:51], v137 offset:64
    s_waitcnt lgkmcnt(6)
    v_mfma_f32_16x16x32_bf16 v[32:35], v[120:123], v[80:83], v[32:35]
    ds_read_b128 v[52:55], v137 offset:576
    v_mfma_f32_16x16x32_bf16 v[16:19], v[120:123], v[84:87], v[16:19]
    ds_read_b128 v[56:59], v137 offset:1088
    v_mfma_f32_16x16x32_bf16 v[20:23], v[120:123], v[88:91], v[20:23]
    ds_read_b128 v[60:63], v137 offset:1600
    v_mfma_f32_16x16x32_bf16 v[36:39], v[120:123], v[92:95], v[36:39]
    ds_read_b128 v[64:67], v137 offset:2112
    v_mfma_f32_16x16x32_bf16 v[40:43], v[120:123], v[96:99], v[40:43]
    ds_read_b64 v[132:133], v136 offset:2432
    v_mfma_f32_16x16x32_bf16 v[24:27], v[120:123], v[100:103], v[24:27]
    ds_read_b64 v[134:135], v136 offset:2440
    v_mfma_f32_16x16x32_bf16 v[28:31], v[120:123], v[104:107], v[28:31]
    ds_read_b128 v[68:71], v137 offset:2624
    v_mfma_f32_16x16x32_bf16 v[44:47], v[120:123], v[108:111], v[44:47]
    ds_read_b128 v[72:75], v137 offset:3136
    s_waitcnt lgkmcnt(12)
    v_mfma_f32_16x16x32_bf16 v[16:19], v[124:127], v[80:83], v[16:19]
    ds_read_b128 v[76:79], v137 offset:3648
    v_mfma_f32_16x16x32_bf16 v[20:23], v[124:127], v[84:87], v[20:23]
    ds_read_b64 v[112:113], v136 offset:1920
    v_mfma_f32_16x16x32_bf16 v[36:39], v[124:127], v[88:91], v[36:39]
    ds_read_b64 v[114:115], v136 offset:1928
    v_mfma_f32_16x16x32_bf16 v[40:43], v[124:127], v[92:95], v[40:43]
    ds_read_b64 v[116:117], v136 offset:1408
    v_mfma_f32_16x16x32_bf16 v[24:27], v[124:127], v[96:99], v[24:27]
    ds_read_b64 v[118:119], v136 offset:1416
    v_mfma_f32_16x16x32_bf16 v[28:31], v[124:127], v[100:103], v[28:31]
    ds_read_b64 v[120:121], v136 offset:896
    v_mfma_f32_16x16x32_bf16 v[44:47], v[124:127], v[104:107], v[44:47]
    ds_read_b64 v[122:123], v136 offset:904
    s_waitcnt lgkmcnt(15)
    v_mfma_f32_16x16x32_bf16 v[20:23], v[128:131], v[80:83], v[20:23]
    ds_read_b64 v[124:125], v136 offset:384
    v_mfma_f32_16x16x32_bf16 v[36:39], v[128:131], v[84:87], v[36:39]
    ds_read_b64 v[126:127], v136 offset:392
    v_mfma_f32_16x16x32_bf16 v[40:43], v[128:131], v[88:91], v[40:43]
    v_mfma_f32_16x16x32_bf16 v[24:27], v[128:131], v[92:95], v[24:27]
    v_mfma_f32_16x16x32_bf16 v[28:31], v[128:131], v[96:99], v[28:31]
    v_mfma_f32_16x16x32_bf16 v[44:47], v[128:131], v[100:103], v[44:47]
    ds_read_b64 v[128:129], v136 offset:3904
    s_waitcnt lgkmcnt(12)
    v_mfma_f32_16x16x32_bf16 v[36:39], v[132:135], v[80:83], v[36:39]
    ds_read_b64 v[130:131], v136 offset:3912
    v_mfma_f32_16x16x32_bf16 v[40:43], v[132:135], v[84:87], v[40:43]
    v_mfma_f32_16x16x32_bf16 v[24:27], v[132:135], v[88:91], v[24:27]
    v_mfma_f32_16x16x32_bf16 v[28:31], v[132:135], v[92:95], v[28:31]
    v_mfma_f32_16x16x32_bf16 v[44:47], v[132:135], v[96:99], v[44:47]
    ds_read_b64 v[132:133], v136 offset:3392
    s_waitcnt lgkmcnt(9)
    v_mfma_f32_16x16x32_bf16 v[40:43], v[112:115], v[80:83], v[40:43]
    ds_read_b64 v[134:135], v136 offset:3400
    v_mfma_f32_16x16x32_bf16 v[24:27], v[112:115], v[84:87], v[24:27]
    v_mfma_f32_16x16x32_bf16 v[28:31], v[112:115], v[88:91], v[28:31]
    v_mfma_f32_16x16x32_bf16 v[44:47], v[112:115], v[92:95], v[44:47]
    ds_read_b64 v[112:113], v136 offset:2880
    s_waitcnt lgkmcnt(9)
    v_mfma_f32_16x16x32_bf16 v[24:27], v[116:119], v[80:83], v[24:27]
    ds_read_b64 v[114:115], v136 offset:2888
    v_mfma_f32_16x16x32_bf16 v[28:31], v[116:119], v[84:87], v[28:31]
    v_mfma_f32_16x16x32_bf16 v[44:47], v[116:119], v[88:91], v[44:47]
    s_waitcnt lgkmcnt(8)
    v_mfma_f32_16x16x32_bf16 v[28:31], v[120:123], v[80:83], v[28:31]
    v_mfma_f32_16x16x32_bf16 v[44:47], v[120:123], v[84:87], v[44:47]
    s_waitcnt lgkmcnt(6)
    v_mfma_f32_16x16x32_bf16 v[44:47], v[124:127], v[80:83], v[44:47]
    ds_read_b128 v[80:83], v137 offset:0
    s_waitcnt lgkmcnt(5)
    v_mfma_f32_16x16x32_bf16 v[32:35], v[128:131], v[48:51], v[32:35]
    ds_read_b128 v[92:95], v137 offset:1536
    v_mfma_f32_16x16x32_bf16 v[16:19], v[128:131], v[52:55], v[16:19]
    ds_read_b128 v[96:99], v137 offset:2048
    v_mfma_f32_16x16x32_bf16 v[20:23], v[128:131], v[56:59], v[20:23]
    ds_read_b128 v[108:111], v137 offset:3584
    v_mfma_f32_16x16x32_bf16 v[36:39], v[128:131], v[60:63], v[36:39]
    ds_read_b128 v[88:91], v137 offset:1024
    v_mfma_f32_16x16x32_bf16 v[40:43], v[128:131], v[64:67], v[40:43]
    ds_read_b64 v[116:117], v136 offset:2368
    v_mfma_f32_16x16x32_bf16 v[24:27], v[128:131], v[68:71], v[24:27]
    ds_read_b64 v[118:119], v136 offset:2376
    v_mfma_f32_16x16x32_bf16 v[28:31], v[128:131], v[72:75], v[28:31]
    ds_read_b128 v[104:107], v137 offset:3072
    v_mfma_f32_16x16x32_bf16 v[44:47], v[128:131], v[76:79], v[44:47]
    ds_read_b128 v[84:87], v137 offset:512
    s_waitcnt lgkmcnt(11)
    v_mfma_f32_16x16x32_bf16 v[16:19], v[132:135], v[48:51], v[16:19]
    ds_read_b128 v[100:103], v137 offset:2560
    v_mfma_f32_16x16x32_bf16 v[20:23], v[132:135], v[52:55], v[20:23]
    ds_read_b64 v[120:121], v136 offset:1856
    v_mfma_f32_16x16x32_bf16 v[36:39], v[132:135], v[56:59], v[36:39]
    ds_read_b64 v[122:123], v136 offset:1864
    v_mfma_f32_16x16x32_bf16 v[40:43], v[132:135], v[60:63], v[40:43]
    ds_read_b64 v[124:125], v136 offset:1344
    v_mfma_f32_16x16x32_bf16 v[24:27], v[132:135], v[64:67], v[24:27]
    ds_read_b64 v[126:127], v136 offset:1352
    v_mfma_f32_16x16x32_bf16 v[28:31], v[132:135], v[68:71], v[28:31]
    ds_read_b64 v[128:129], v136 offset:832
    v_mfma_f32_16x16x32_bf16 v[44:47], v[132:135], v[72:75], v[44:47]
    ds_read_b64 v[130:131], v136 offset:840
    s_waitcnt lgkmcnt(15)
    v_mfma_f32_16x16x32_bf16 v[20:23], v[112:115], v[48:51], v[20:23]
    ds_read_b64 v[132:133], v136 offset:320
    v_mfma_f32_16x16x32_bf16 v[36:39], v[112:115], v[52:55], v[36:39]
    ds_read_b64 v[134:135], v136 offset:328
    v_mfma_f32_16x16x32_bf16 v[40:43], v[112:115], v[56:59], v[40:43]
    v_mfma_f32_16x16x32_bf16 v[24:27], v[112:115], v[60:63], v[24:27]
    v_mfma_f32_16x16x32_bf16 v[28:31], v[112:115], v[64:67], v[28:31]
    v_mfma_f32_16x16x32_bf16 v[44:47], v[112:115], v[68:71], v[44:47]
    ds_read_b64 v[112:113], v136 offset:3840
    s_waitcnt lgkmcnt(12)
    v_mfma_f32_16x16x32_bf16 v[36:39], v[116:119], v[48:51], v[36:39]
    ds_read_b64 v[114:115], v136 offset:3848
    v_mfma_f32_16x16x32_bf16 v[40:43], v[116:119], v[52:55], v[40:43]
    v_mfma_f32_16x16x32_bf16 v[24:27], v[116:119], v[56:59], v[24:27]
    v_mfma_f32_16x16x32_bf16 v[28:31], v[116:119], v[60:63], v[28:31]
    v_mfma_f32_16x16x32_bf16 v[44:47], v[116:119], v[64:67], v[44:47]
    ds_read_b64 v[116:117], v136 offset:3328
    s_waitcnt lgkmcnt(9)
    v_mfma_f32_16x16x32_bf16 v[40:43], v[120:123], v[48:51], v[40:43]
    ds_read_b64 v[118:119], v136 offset:3336
    v_mfma_f32_16x16x32_bf16 v[24:27], v[120:123], v[52:55], v[24:27]
    v_mfma_f32_16x16x32_bf16 v[28:31], v[120:123], v[56:59], v[28:31]
    v_mov_b32 v10, 12
    v_mfma_f32_16x16x32_bf16 v[44:47], v[120:123], v[60:63], v[44:47]
    ds_read_b64 v[120:121], v136 offset:2816
    s_waitcnt lgkmcnt(9)
    v_mfma_f32_16x16x32_bf16 v[24:27], v[124:127], v[48:51], v[24:27]
    ds_read_b64 v[122:123], v136 offset:2824
    v_mfma_f32_16x16x32_bf16 v[28:31], v[124:127], v[52:55], v[28:31]
    v_mfma_f32_16x16x32_bf16 v[44:47], v[124:127], v[56:59], v[44:47]
    ds_read_b64 v[124:125], v136 offset:2304
    ds_read_b64 v[126:127], v136 offset:2312
    s_waitcnt lgkmcnt(10)
    v_mfma_f32_16x16x32_bf16 v[28:31], v[128:131], v[48:51], v[28:31]
    v_mfma_f32_16x16x32_bf16 v[44:47], v[128:131], v[52:55], v[44:47]
    ds_read_b64 v[128:129], v136 offset:1792
    ds_read_b64 v[130:131], v136 offset:1800
    s_waitcnt lgkmcnt(10)
    v_mfma_f32_16x16x32_bf16 v[44:47], v[132:135], v[48:51], v[44:47]
    ds_read_b64 v[132:133], v136 offset:1280
    ds_read_b64 v[134:135], v136 offset:1288
    s_waitcnt lgkmcnt(10)
    v_mfma_f32_16x16x32_bf16 v[32:35], v[112:115], v[80:83], v[32:35]
    v_mfma_f32_16x16x32_bf16 v[36:39], v[112:115], v[92:95], v[36:39]
    v_mfma_f32_16x16x32_bf16 v[40:43], v[112:115], v[96:99], v[40:43]
    ds_read_b128 v[48:51], v143 offset:512
    ds_read_b128 v[52:55], v143 offset:2560
    v_mfma_f32_16x16x32_bf16 v[44:47], v[112:115], v[108:111], v[44:47]
    ds_read_b64 v[112:113], v136 offset:768
    ds_read_b64 v[114:115], v136 offset:776
    s_waitcnt lgkmcnt(12)
    v_mfma_f32_16x16x32_bf16 v[36:39], v[116:119], v[88:91], v[36:39]
    ds_write_b128 v139, v[32:35] offset:0
    v_mfma_f32_16x16x32_bf16 v[40:43], v[116:119], v[92:95], v[40:43]
    v_mfma_f32_16x16x32_bf16 v[44:47], v[116:119], v[104:107], v[44:47]
    ds_read_b64 v[116:117], v136 offset:256
    ds_read_b64 v[118:119], v136 offset:264
    s_waitcnt lgkmcnt(13)
    v_mfma_f32_16x16x32_bf16 v[36:39], v[120:123], v[84:87], v[36:39]
    v_mfma_f32_16x16x32_bf16 v[40:43], v[120:123], v[88:91], v[40:43]
    v_mfma_f32_16x16x32_bf16 v[44:47], v[120:123], v[100:103], v[44:47]
    ds_read_b64 v[120:121], v136 offset:3840
    ds_read_b64 v[122:123], v136 offset:3848
    s_waitcnt lgkmcnt(13)
    v_mfma_f32_16x16x32_bf16 v[36:39], v[124:127], v[80:83], v[36:39]
    v_mfma_f32_16x16x32_bf16 v[40:43], v[124:127], v[84:87], v[40:43]
    v_mfma_f32_16x16x32_bf16 v[44:47], v[124:127], v[96:99], v[44:47]
    ds_read_b64 v[124:125], v136 offset:3328
    ds_read_b64 v[126:127], v136 offset:3336
    s_waitcnt lgkmcnt(13)
    v_mfma_f32_16x16x32_bf16 v[40:43], v[128:131], v[80:83], v[40:43]
    v_mfma_f32_16x16x32_bf16 v[44:47], v[128:131], v[92:95], v[44:47]
    ds_read_b64 v[128:129], v136 offset:2816
    ds_read_b64 v[130:131], v136 offset:2824
    ds_write_b128 v139, v[36:39] offset:1024
    s_waitcnt lgkmcnt(14)
    v_mfma_f32_16x16x32_bf16 v[44:47], v[132:135], v[88:91], v[44:47]
    ds_read_b64 v[132:133], v136 offset:2304
    ds_read_b64 v[134:135], v136 offset:2312
    s_waitcnt lgkmcnt(12)
    v_mfma_f32_16x16x32_bf16 v[44:47], v[112:115], v[84:87], v[44:47]
    ds_read_b64 v[112:113], v136 offset:1792
    ds_read_b64 v[114:115], v136 offset:1800
    v_lshlrev_b32 v56, 16, v48
    s_waitcnt lgkmcnt(11)
    v_mfma_f32_16x16x32_bf16 v[44:47], v[116:119], v[80:83], v[44:47]
    ds_read_b64 v[116:117], v136 offset:1280
    ds_read_b64 v[118:119], v136 offset:1288
    ds_write_b128 v139, v[40:43] offset:2048
    v_and_b32 v57, 0xffff0000, v48
    s_waitcnt lgkmcnt(12)
    v_mfma_f32_16x16x32_bf16 v[16:19], v[120:123], v[84:87], v[16:19]
    v_lshlrev_b32 v58, 16, v49
    v_mfma_f32_16x16x32_bf16 v[20:23], v[120:123], v[88:91], v[20:23]
    v_and_b32 v59, 0xffff0000, v49
    v_mfma_f32_16x16x32_bf16 v[24:27], v[120:123], v[100:103], v[24:27]
    v_lshlrev_b32 v60, 16, v50
    v_mfma_f32_16x16x32_bf16 v[28:31], v[120:123], v[104:107], v[28:31]
    ds_read_b64 v[120:121], v136 offset:768
    ds_read_b64 v[122:123], v136 offset:776
    ds_write_b128 v139, v[44:47] offset:3072
    ds_write_b32 v8, v10
    v_and_b32 v61, 0xffff0000, v50
    s_waitcnt lgkmcnt(14)
    v_mfma_f32_16x16x32_bf16 v[16:19], v[124:127], v[80:83], v[16:19]
    v_lshlrev_b32 v62, 16, v51
    v_mfma_f32_16x16x32_bf16 v[20:23], v[124:127], v[84:87], v[20:23]
    v_and_b32 v63, 0xffff0000, v51
    v_mfma_f32_16x16x32_bf16 v[24:27], v[124:127], v[96:99], v[24:27]
    v_lshlrev_b32 v64, 16, v52
    v_mfma_f32_16x16x32_bf16 v[28:31], v[124:127], v[100:103], v[28:31]
    v_and_b32 v65, 0xffff0000, v52
    s_waitcnt lgkmcnt(12)
    v_mfma_f32_16x16x32_bf16 v[20:23], v[128:131], v[80:83], v[20:23]
    v_lshlrev_b32 v66, 16, v53
    v_mfma_f32_16x16x32_bf16 v[24:27], v[128:131], v[92:95], v[24:27]
    v_and_b32 v67, 0xffff0000, v53
    v_mfma_f32_16x16x32_bf16 v[28:31], v[128:131], v[96:99], v[28:31]
    v_lshlrev_b32 v68, 16, v54
    s_waitcnt lgkmcnt(9)
    v_mfma_f32_16x16x32_bf16 v[24:27], v[132:135], v[88:91], v[24:27]
    v_and_b32 v69, 0xffff0000, v54
    v_mfma_f32_16x16x32_bf16 v[28:31], v[132:135], v[92:95], v[28:31]
    v_lshlrev_b32 v70, 16, v55
    s_waitcnt lgkmcnt(7)
    v_mfma_f32_16x16x32_bf16 v[24:27], v[112:115], v[84:87], v[24:27]
    v_and_b32 v71, 0xffff0000, v55
    ds_read_b32 v72, v12
    v_mfma_f32_16x16x32_bf16 v[28:31], v[112:115], v[88:91], v[28:31]
    s_waitcnt lgkmcnt(6)
    v_mfma_f32_16x16x32_bf16 v[24:27], v[116:119], v[80:83], v[24:27]
    v_mfma_f32_16x16x32_bf16 v[28:31], v[116:119], v[84:87], v[28:31]
    s_waitcnt lgkmcnt(3)
    v_mfma_f32_16x16x32_bf16 v[28:31], v[120:123], v[80:83], v[28:31]
    s_waitcnt lgkmcnt(0)
    v_cmp_gt_u32 vcc, 12, v72
    s_nop 4
    s_cbranch_vccnz Lretry26
Ldone26:
    ds_read_b128 v[32:35], v140 offset:0
    ds_read_b128 v[36:39], v140 offset:1024
    ds_read_b128 v[40:43], v140 offset:2048
    ds_read_b128 v[44:47], v140 offset:3072
    v_mov_b32 v10, 13
    ds_write_b32 v8, v10
    s_waitcnt lgkmcnt(1)
    s_load_dword s50, s[30:31], s48 glc
    v_add_f32 v16, v16, v32
    v_add_f32 v17, v17, v33
    v_add_f32 v18, v18, v34
    v_add_f32 v19, v19, v35
    v_add_f32 v20, v20, v36
    v_add_f32 v21, v21, v37
    v_add_f32 v22, v22, v38
    v_add_f32 v23, v23, v39
    v_permlane16_swap_b32 v16, v20
    v_permlane16_swap_b32 v17, v21
    v_permlane16_swap_b32 v18, v22
    v_permlane16_swap_b32 v19, v23
    v_fmac_f32 v16, s93, v56
    v_fmac_f32 v17, s93, v57
    v_fmac_f32 v18, s93, v58
    v_fmac_f32 v19, s93, v59
    v_fmac_f32 v20, s93, v60
    v_fmac_f32 v21, s93, v61
    v_fmac_f32 v22, s93, v62
    v_fmac_f32 v23, s93, v63
    v_cvt_pk_bf16_f32 v48, v16, v17
    v_cvt_pk_bf16_f32 v49, v18, v19
    v_cvt_pk_bf16_f32 v50, v20, v21
    v_cvt_pk_bf16_f32 v51, v22, v23
    v_add_f32 v24, v24, v40
    v_add_f32 v25, v25, v41
    v_add_f32 v26, v26, v42
    v_add_f32 v27, v27, v43
    v_add_f32 v28, v28, v44
    v_add_f32 v29, v29, v45
    v_add_f32 v30, v30, v46
    v_add_f32 v31, v31, v47
    v_permlane16_swap_b32 v24, v28
    v_permlane16_swap_b32 v25, v29
    v_permlane16_swap_b32 v26, v30
    v_permlane16_swap_b32 v27, v31
    v_fmac_f32 v24, s93, v64
    v_fmac_f32 v25, s93, v65
    v_fmac_f32 v26, s93, v66
    v_fmac_f32 v27, s93, v67
    v_fmac_f32 v28, s93, v68
    v_fmac_f32 v29, s93, v69
    v_fmac_f32 v30, s93, v70
    v_fmac_f32 v31, s93, v71
    v_cvt_pk_bf16_f32 v52, v24, v25
    v_cvt_pk_bf16_f32 v53, v26, v27
    v_cvt_pk_bf16_f32 v54, v28, v29
    v_cvt_pk_bf16_f32 v55, v30, v31
    buffer_store_dwordx4 v[48:51], v141, s[44:47], s32 offen offset:512 sc1
    buffer_store_dwordx4 v[52:55], v141, s[44:47], s32 offen offset:2560 sc1
    s_nop 1
LYg2:
    s_waitcnt lgkmcnt(0)
    s_cmp_lt_u32 s50, 14
    s_cbranch_scc1 Lretry27
Ldone27:
    buffer_load_dwordx4 v[80:83], v5, s[44:47], s83 offen sc1
    buffer_load_dwordx4 v[84:87], v5, s[44:47], s84 offen sc1
    buffer_load_dwordx4 v[88:91], v5, s[44:47], s85 offen sc1
    buffer_load_dwordx4 v[92:95], v5, s[44:47], s86 offen sc1
    buffer_load_dwordx4 v[96:99], v5, s[44:47], s87 offen sc1
    buffer_load_dwordx4 v[100:103], v5, s[44:47], s88 offen sc1
    s_waitcnt vmcnt(6)
    s_mov_b32 s51, 1
    s_atomic_add s51, s[30:31], s33
    buffer_load_dwordx4 v[104:107], v5, s[44:47], s89 offen sc1
    v_add_u32 v5, 57344, v5
    buffer_load_dwordx4 v[108:111], v5, s[44:47], s83 offen sc1
    buffer_load_dwordx4 v[112:115], v5, s[44:47], s84 offen sc1
    s_load_dword s50, s[30:31], s49 glc
    ds_read_b128 v[136:139], v11 offset:16
    s_waitcnt vmcnt(8)
    v_mfma_f32_16x16x32_bf16 v[16:19], v[144:147], v[80:83], 0
    v_and_b32 v12, 15, v1
    v_mfma_f32_16x16x32_bf16 v[20:23], v[148:151], v[80:83], 0
    v_lshrrev_b32 v117, 4, v1
    v_mfma_f32_16x16x32_bf16 v[24:27], v[152:155], v[80:83], 0
    v_xor_b32 v13, v12, v117
    v_mfma_f32_16x16x32_bf16 v[28:31], v[156:159], v[80:83], 0
    s_lshl_b32 s72, s67, 14
    buffer_load_dwordx4 v[80:83], v5, s[44:47], s85 offen sc1
    s_waitcnt vmcnt(8)
    v_mfma_f32_16x16x32_bf16 v[16:19], v[160:163], v[84:87], v[16:19]
    v_lshl_add_u32 v140, v12, 8, s72
    v_mfma_f32_16x16x32_bf16 v[20:23], v[164:167], v[84:87], v[20:23]
    v_lshl_add_u32 v140, v13, 4, v140
    v_mfma_f32_16x16x32_bf16 v[24:27], v[168:171], v[84:87], v[24:27]
    v_xor_b32 v141, 64, v140
    v_mfma_f32_16x16x32_bf16 v[28:31], v[172:175], v[84:87], v[28:31]
    v_xor_b32 v142, 128, v140
    buffer_load_dwordx4 v[84:87], v5, s[44:47], s86 offen sc1
    s_waitcnt vmcnt(8)
    v_mfma_f32_16x16x32_bf16 v[16:19], v[176:179], v[88:91], v[16:19]
    v_xor_b32 v143, 192, v140
    v_mfma_f32_16x16x32_bf16 v[20:23], v[180:183], v[88:91], v[20:23]
    s_lshl_b32 s70, s94, 4
    v_mfma_f32_16x16x32_bf16 v[24:27], v[184:187], v[88:91], v[24:27]
    v_add_u32 v116, s70, v12
    v_mfma_f32_16x16x32_bf16 v[28:31], v[188:191], v[88:91], v[28:31]
    s_lshr_b32 s71, s67, 2
    buffer_load_dwordx4 v[88:91], v5, s[44:47], s87 offen sc1
    s_waitcnt vmcnt(8)
    v_mfma_f32_16x16x32_bf16 v[16:19], v[192:195], v[92:95], v[16:19]
    s_lshl_b32 s72, s65, 16
    v_mfma_f32_16x16x32_bf16 v[20:23], v[196:199], v[92:95], v[20:23]
    s_lshl_b32 s73, s66, 7
    v_mfma_f32_16x16x32_bf16 v[24:27], v[200:203], v[92:95], v[24:27]
    s_add_u32 s72, s72, s73
    v_mfma_f32_16x16x32_bf16 v[28:31], v[204:207], v[92:95], v[28:31]
    s_lshl_b32 s73, s71, 6
    buffer_load_dwordx4 v[92:95], v5, s[44:47], s88 offen sc1
    s_waitcnt vmcnt(8)
    v_mfma_f32_16x16x32_bf16 v[16:19], v[208:211], v[96:99], v[16:19]
    s_add_u32 s72, s72, s73
    v_mfma_f32_16x16x32_bf16 v[20:23], v[212:215], v[96:99], v[20:23]
    v_lshl_add_u32 v118, v116, 10, s72
    v_mfma_f32_16x16x32_bf16 v[24:27], v[216:219], v[96:99], v[24:27]
    v_lshl_add_u32 v118, v117, 4, v118
    v_mfma_f32_16x16x32_bf16 v[28:31], v[220:223], v[96:99], v[28:31]
    s_lshl_b32 s72, s71, 3
    buffer_load_dwordx4 v[96:99], v5, s[44:47], s89 offen sc1
    s_waitcnt vmcnt(8)
    v_mfma_f32_16x16x32_bf16 v[16:19], v[224:227], v[100:103], v[16:19]
    v_lshl_add_u32 v13, v117, 1, s72
    v_mfma_f32_16x16x32_bf16 v[20:23], v[228:231], v[100:103], v[20:23]
    v_xor_b32 v13, v12, v13
    v_mfma_f32_16x16x32_bf16 v[24:27], v[232:235], v[100:103], v[24:27]
    v_lshlrev_b32 v124, 8, v116
    v_mfma_f32_16x16x32_bf16 v[28:31], v[236:239], v[100:103], v[28:31]
    v_lshl_add_u32 v124, v13, 4, v124
    s_waitcnt lgkmcnt(0)
    s_cmp_lt_u32 s50, 14
    s_cbranch_scc1 Lretry28
Ldone28:
    v_add_u32 v5, 57344, v5
    buffer_load_dwordx4 v[100:103], v5, s[44:47], s83 offen sc1
    s_waitcnt vmcnt(8)
    v_mfma_f32_16x16x32_bf16 v[16:19], v[240:243], v[104:107], v[16:19]
    v_xor_b32 v125, 16, v124
    v_mfma_f32_16x16x32_bf16 v[20:23], v[244:247], v[104:107], v[20:23]
    v_add_u32 v126, 0x10000, v124
    v_mfma_f32_16x16x32_bf16 v[24:27], v[248:251], v[104:107], v[24:27]
    v_add_u32 v127, 0x10000, v125
    v_mfma_f32_16x16x32_bf16 v[28:31], v[252:255], v[104:107], v[28:31]
    v_bfe_u32 v12, v1, 2, 2
    v_min_u32 v136, v136, v137
    v_min3_u32 v136, v136, v138, v139
    v_cmp_gt_u32 vcc, 13, v136
    s_nop 4
    s_cbranch_vccnz Lretry29
Ldone29:
    buffer_load_dwordx4 v[104:107], v5, s[44:47], s84 offen sc1
    s_waitcnt vmcnt(8)
    v_mfma_f32_16x16x32_bf16 v[32:35], v[144:147], v[108:111], 0
    v_lshl_add_u32 v12, v117, 3, v12
    v_mfma_f32_16x16x32_bf16 v[36:39], v[148:151], v[108:111], 0
    v_lshlrev_b32 v12, 7, v12
    v_mfma_f32_16x16x32_bf16 v[40:43], v[152:155], v[108:111], 0
    v_and_b32 v13, 3, v1
    v_mfma_f32_16x16x32_bf16 v[44:47], v[156:159], v[108:111], 0
    v_lshl_add_u32 v12, v13, 3, v12
    buffer_load_dwordx4 v[108:111], v5, s[44:47], s85 offen sc1
    s_waitcnt vmcnt(8)
    v_mfma_f32_16x16x32_bf16 v[32:35], v[160:163], v[112:115], v[32:35]
    s_lshl_b32 s72, s71, 12
    v_mfma_f32_16x16x32_bf16 v[36:39], v[164:167], v[112:115], v[36:39]
    s_lshl_b32 s73, s70, 1
    v_mfma_f32_16x16x32_bf16 v[40:43], v[168:171], v[112:115], v[40:43]
    s_add_u32 s72, s72, s73
    v_mfma_f32_16x16x32_bf16 v[44:47], v[172:175], v[112:115], v[44:47]
    s_add_u32 s72, s72, 147968
    ds_write_b128 v140, v[16:19] offset:0
    buffer_load_dwordx4 v[112:115], v5, s[44:47], s86 offen sc1
    s_waitcnt vmcnt(8)
    v_mfma_f32_16x16x32_bf16 v[32:35], v[176:179], v[80:83], v[32:35]
    v_add_u32 v119, s72, v12
    v_mfma_f32_16x16x32_bf16 v[36:39], v[180:183], v[80:83], v[36:39]
    v_mfma_f32_16x16x32_bf16 v[40:43], v[184:187], v[80:83], v[40:43]
    v_mfma_f32_16x16x32_bf16 v[44:47], v[188:191], v[80:83], v[44:47]
    ds_write_b128 v141, v[20:23] offset:0
    buffer_load_dwordx4 v[80:83], v5, s[44:47], s87 offen sc1
    s_waitcnt vmcnt(8)
    v_mfma_f32_16x16x32_bf16 v[32:35], v[192:195], v[84:87], v[32:35]
    v_mfma_f32_16x16x32_bf16 v[36:39], v[196:199], v[84:87], v[36:39]
    v_mfma_f32_16x16x32_bf16 v[40:43], v[200:203], v[84:87], v[40:43]
    v_mfma_f32_16x16x32_bf16 v[44:47], v[204:207], v[84:87], v[44:47]
    ds_write_b128 v142, v[24:27] offset:0
    buffer_load_dwordx4 v[84:87], v5, s[44:47], s88 offen sc1
    s_waitcnt vmcnt(8)
    v_mfma_f32_16x16x32_bf16 v[32:35], v[208:211], v[88:91], v[32:35]
    v_mfma_f32_16x16x32_bf16 v[36:39], v[212:215], v[88:91], v[36:39]
    v_mfma_f32_16x16x32_bf16 v[40:43], v[216:219], v[88:91], v[40:43]
    v_mfma_f32_16x16x32_bf16 v[44:47], v[220:223], v[88:91], v[44:47]
    ds_write_b128 v143, v[28:31] offset:0
    buffer_load_dwordx4 v[88:91], v5, s[44:47], s89 offen sc1
    s_waitcnt vmcnt(8)
    v_mfma_f32_16x16x32_bf16 v[32:35], v[224:227], v[92:95], v[32:35]
    v_mfma_f32_16x16x32_bf16 v[36:39], v[228:231], v[92:95], v[36:39]
    v_mfma_f32_16x16x32_bf16 v[40:43], v[232:235], v[92:95], v[40:43]
    v_mfma_f32_16x16x32_bf16 v[44:47], v[236:239], v[92:95], v[44:47]
    v_add_u32 v5, 57344, v5
    buffer_load_dwordx4 v[92:95], v5, s[44:47], s83 offen sc1
    s_waitcnt vmcnt(8)
    v_mfma_f32_16x16x32_bf16 v[32:35], v[240:243], v[96:99], v[32:35]
    v_mfma_f32_16x16x32_bf16 v[36:39], v[244:247], v[96:99], v[36:39]
    v_mfma_f32_16x16x32_bf16 v[40:43], v[248:251], v[96:99], v[40:43]
    v_mfma_f32_16x16x32_bf16 v[44:47], v[252:255], v[96:99], v[44:47]
    buffer_load_dwordx4 v[96:99], v5, s[44:47], s84 offen sc1
    s_waitcnt vmcnt(8)
    v_mfma_f32_16x16x32_bf16 v[48:51], v[144:147], v[100:103], 0
    v_mfma_f32_16x16x32_bf16 v[52:55], v[148:151], v[100:103], 0
    v_mfma_f32_16x16x32_bf16 v[56:59], v[152:155], v[100:103], 0
    v_mfma_f32_16x16x32_bf16 v[60:63], v[156:159], v[100:103], 0
    buffer_load_dwordx4 v[100:103], v5, s[44:47], s85 offen sc1
    s_waitcnt vmcnt(8)
    v_mfma_f32_16x16x32_bf16 v[48:51], v[160:163], v[104:107], v[48:51]
    v_mfma_f32_16x16x32_bf16 v[52:55], v[164:167], v[104:107], v[52:55]
    v_mfma_f32_16x16x32_bf16 v[56:59], v[168:171], v[104:107], v[56:59]
    v_mfma_f32_16x16x32_bf16 v[60:63], v[172:175], v[104:107], v[60:63]
    ds_write_b128 v140, v[32:35] offset:4096
    buffer_load_dwordx4 v[104:107], v5, s[44:47], s86 offen sc1
    s_waitcnt vmcnt(8)
    v_mfma_f32_16x16x32_bf16 v[48:51], v[176:179], v[108:111], v[48:51]
    v_mfma_f32_16x16x32_bf16 v[52:55], v[180:183], v[108:111], v[52:55]
    v_mfma_f32_16x16x32_bf16 v[56:59], v[184:187], v[108:111], v[56:59]
    v_mfma_f32_16x16x32_bf16 v[60:63], v[188:191], v[108:111], v[60:63]
    ds_write_b128 v141, v[36:39] offset:4096
    buffer_load_dwordx4 v[108:111], v5, s[44:47], s87 offen sc1
    s_waitcnt vmcnt(8)
    v_mfma_f32_16x16x32_bf16 v[48:51], v[192:195], v[112:115], v[48:51]
    v_mfma_f32_16x16x32_bf16 v[52:55], v[196:199], v[112:115], v[52:55]
    v_mfma_f32_16x16x32_bf16 v[56:59], v[200:203], v[112:115], v[56:59]
    v_mfma_f32_16x16x32_bf16 v[60:63], v[204:207], v[112:115], v[60:63]
    ds_write_b128 v142, v[40:43] offset:4096
    buffer_load_dwordx4 v[112:115], v5, s[44:47], s88 offen sc1
    s_waitcnt vmcnt(8)
    v_mfma_f32_16x16x32_bf16 v[48:51], v[208:211], v[80:83], v[48:51]
    v_mfma_f32_16x16x32_bf16 v[52:55], v[212:215], v[80:83], v[52:55]
    v_mfma_f32_16x16x32_bf16 v[56:59], v[216:219], v[80:83], v[56:59]
    v_mfma_f32_16x16x32_bf16 v[60:63], v[220:223], v[80:83], v[60:63]
    ds_write_b128 v143, v[44:47] offset:4096
    buffer_load_dwordx4 v[80:83], v5, s[44:47], s89 offen sc1
    global_load_dwordx4 v[120:123], v118, s[4:5]
    s_waitcnt vmcnt(9)
    v_mfma_f32_16x16x32_bf16 v[48:51], v[224:227], v[84:87], v[48:51]
    v_mfma_f32_16x16x32_bf16 v[52:55], v[228:231], v[84:87], v[52:55]
    v_mfma_f32_16x16x32_bf16 v[56:59], v[232:235], v[84:87], v[56:59]
    v_mfma_f32_16x16x32_bf16 v[60:63], v[236:239], v[84:87], v[60:63]
    s_waitcnt vmcnt(8)
    v_mfma_f32_16x16x32_bf16 v[48:51], v[240:243], v[88:91], v[48:51]
    v_mfma_f32_16x16x32_bf16 v[52:55], v[244:247], v[88:91], v[52:55]
    v_mfma_f32_16x16x32_bf16 v[56:59], v[248:251], v[88:91], v[56:59]
    v_mfma_f32_16x16x32_bf16 v[60:63], v[252:255], v[88:91], v[60:63]
    s_waitcnt vmcnt(7)
    v_mfma_f32_16x16x32_bf16 v[64:67], v[144:147], v[92:95], 0
    v_mfma_f32_16x16x32_bf16 v[68:71], v[148:151], v[92:95], 0
    v_mfma_f32_16x16x32_bf16 v[72:75], v[152:155], v[92:95], 0
    v_mfma_f32_16x16x32_bf16 v[76:79], v[156:159], v[92:95], 0
    s_waitcnt vmcnt(6)
    v_mfma_f32_16x16x32_bf16 v[64:67], v[160:163], v[96:99], v[64:67]
    v_mfma_f32_16x16x32_bf16 v[68:71], v[164:167], v[96:99], v[68:71]
    v_mfma_f32_16x16x32_bf16 v[72:75], v[168:171], v[96:99], v[72:75]
    v_mfma_f32_16x16x32_bf16 v[76:79], v[172:175], v[96:99], v[76:79]
    ds_write_b128 v140, v[48:51] offset:8192
    s_waitcnt vmcnt(5)
    v_mfma_f32_16x16x32_bf16 v[64:67], v[176:179], v[100:103], v[64:67]
    v_mfma_f32_16x16x32_bf16 v[68:71], v[180:183], v[100:103], v[68:71]
    v_mfma_f32_16x16x32_bf16 v[72:75], v[184:187], v[100:103], v[72:75]
    v_mfma_f32_16x16x32_bf16 v[76:79], v[188:191], v[100:103], v[76:79]
    ds_write_b128 v141, v[52:55] offset:8192
    s_waitcnt vmcnt(4)
    v_mfma_f32_16x16x32_bf16 v[64:67], v[192:195], v[104:107], v[64:67]
    v_mfma_f32_16x16x32_bf16 v[68:71], v[196:199], v[104:107], v[68:71]
    v_mfma_f32_16x16x32_bf16 v[72:75], v[200:203], v[104:107], v[72:75]
    v_mfma_f32_16x16x32_bf16 v[76:79], v[204:207], v[104:107], v[76:79]
    ds_write_b128 v142, v[56:59] offset:8192
    s_waitcnt vmcnt(3)
    v_mfma_f32_16x16x32_bf16 v[64:67], v[208:211], v[108:111], v[64:67]
    v_mfma_f32_16x16x32_bf16 v[68:71], v[212:215], v[108:111], v[68:71]
    v_mfma_f32_16x16x32_bf16 v[72:75], v[216:219], v[108:111], v[72:75]
    v_mfma_f32_16x16x32_bf16 v[76:79], v[220:223], v[108:111], v[76:79]
    ds_write_b128 v143, v[60:63] offset:8192
    s_waitcnt vmcnt(2)
    v_mfma_f32_16x16x32_bf16 v[64:67], v[224:227], v[112:115], v[64:67]
    v_mfma_f32_16x16x32_bf16 v[68:71], v[228:231], v[112:115], v[68:71]
    v_mfma_f32_16x16x32_bf16 v[72:75], v[232:235], v[112:115], v[72:75]
    v_mfma_f32_16x16x32_bf16 v[76:79], v[236:239], v[112:115], v[76:79]
    s_waitcnt vmcnt(1)
    v_mfma_f32_16x16x32_bf16 v[64:67], v[240:243], v[80:83], v[64:67]
    v_mfma_f32_16x16x32_bf16 v[68:71], v[244:247], v[80:83], v[68:71]
    v_mfma_f32_16x16x32_bf16 v[72:75], v[248:251], v[80:83], v[72:75]
    v_mfma_f32_16x16x32_bf16 v[76:79], v[252:255], v[80:83], v[76:79]
    s_nop 4
    ds_write_b128 v140, v[64:67] offset:12288
    ds_write_b128 v141, v[68:71] offset:12288
    ds_write_b128 v142, v[72:75] offset:12288
    ds_write_b128 v143, v[76:79] offset:12288
    s_waitcnt vmcnt(0) lgkmcnt(0)
Lfinal:
    v_lshlrev_b32 v88, 16, v120
    v_and_b32 v89, 0xffff0000, v120
    v_lshlrev_b32 v90, 16, v121
    v_and_b32 v91, 0xffff0000, v121
    v_lshlrev_b32 v92, 16, v122
    v_and_b32 v93, 0xffff0000, v122
    v_lshlrev_b32 v94, 16, v123
    v_and_b32 v95, 0xffff0000, v123
    s_mov_b32 s72, 0x3fb8aa3b
    s_barrier
    ds_read_b128 v[16:19], v124 offset:0
    ds_read_b128 v[20:23], v125 offset:0
    ds_read_b128 v[24:27], v124 offset:16384
    ds_read_b128 v[28:31], v125 offset:16384
    ds_read_b128 v[32:35], v124 offset:32768
    ds_read_b128 v[36:39], v125 offset:32768
    ds_read_b128 v[40:43], v124 offset:49152
    ds_read_b128 v[44:47], v125 offset:49152
    ds_read_b128 v[48:51], v126 offset:0
    ds_read_b128 v[52:55], v127 offset:0
    ds_read_b128 v[56:59], v126 offset:16384
    ds_read_b128 v[60:63], v127 offset:16384
    ds_read_b128 v[64:67], v126 offset:32768
    ds_read_b128 v[68:71], v127 offset:32768
    ds_read_b128 v[72:75], v126 offset:49152
    ds_read_b128 v[76:79], v127 offset:49152
    ds_read_b64_tr_b16 v[160:161], v119
    ds_read_b64_tr_b16 v[162:163], v119 offset:512
    s_waitcnt lgkmcnt(14)
    v_pk_add_f32 v[16:17], v[16:17], v[24:25]
    v_pk_add_f32 v[18:19], v[18:19], v[26:27]
    v_pk_add_f32 v[20:21], v[20:21], v[28:29]
    v_pk_add_f32 v[22:23], v[22:23], v[30:31]
    s_waitcnt lgkmcnt(12)
    v_pk_add_f32 v[16:17], v[16:17], v[32:33]
    v_pk_add_f32 v[18:19], v[18:19], v[34:35]
    v_pk_add_f32 v[20:21], v[20:21], v[36:37]
    v_pk_add_f32 v[22:23], v[22:23], v[38:39]
    s_waitcnt lgkmcnt(10)
    v_pk_add_f32 v[16:17], v[16:17], v[40:41]
    v_pk_add_f32 v[18:19], v[18:19], v[42:43]
    v_pk_add_f32 v[20:21], v[20:21], v[44:45]
    v_pk_add_f32 v[22:23], v[22:23], v[46:47]
    s_waitcnt lgkmcnt(8)
    v_pk_add_f32 v[16:17], v[16:17], v[48:49]
    v_pk_add_f32 v[18:19], v[18:19], v[50:51]
    v_pk_add_f32 v[20:21], v[20:21], v[52:53]
    v_pk_add_f32 v[22:23], v[22:23], v[54:55]
    s_waitcnt lgkmcnt(6)
    v_pk_add_f32 v[16:17], v[16:17], v[56:57]
    v_pk_add_f32 v[18:19], v[18:19], v[58:59]
    v_pk_add_f32 v[20:21], v[20:21], v[60:61]
    v_pk_add_f32 v[22:23], v[22:23], v[62:63]
    s_waitcnt lgkmcnt(4)
    v_pk_add_f32 v[16:17], v[16:17], v[64:65]
    v_pk_add_f32 v[18:19], v[18:19], v[66:67]
    v_pk_add_f32 v[20:21], v[20:21], v[68:69]
    v_pk_add_f32 v[22:23], v[22:23], v[70:71]
    s_waitcnt lgkmcnt(2)
    v_pk_add_f32 v[16:17], v[16:17], v[72:73]
    v_pk_add_f32 v[18:19], v[18:19], v[74:75]
    v_pk_add_f32 v[20:21], v[20:21], v[76:77]
    v_pk_add_f32 v[22:23], v[22:23], v[78:79]
    v_exp_f32 v24, -v16
    v_exp_f32 v25, -v17
    v_exp_f32 v26, -v18
    v_exp_f32 v27, -v19
    v_exp_f32 v28, -v20
    v_exp_f32 v29, -v21
    v_exp_f32 v30, -v22
    v_exp_f32 v31, -v23
    s_waitcnt lgkmcnt(0)
    v_lshlrev_b32 v32, 16, v160
    v_and_b32 v33, 0xffff0000, v160
    v_lshlrev_b32 v34, 16, v161
    v_and_b32 v35, 0xffff0000, v161
    v_lshlrev_b32 v36, 16, v162
    v_and_b32 v37, 0xffff0000, v162
    v_lshlrev_b32 v38, 16, v163
    v_and_b32 v39, 0xffff0000, v163
    v_pk_fma_f32 v[24:25], v[24:25], s[72:73], s[72:73] op_sel_hi:[1,0,0]
    v_pk_fma_f32 v[26:27], v[26:27], s[72:73], s[72:73] op_sel_hi:[1,0,0]
    v_pk_fma_f32 v[28:29], v[28:29], s[72:73], s[72:73] op_sel_hi:[1,0,0]
    v_pk_fma_f32 v[30:31], v[30:31], s[72:73], s[72:73] op_sel_hi:[1,0,0]
    v_pk_mul_f32 v[16:17], v[16:17], v[32:33]
    v_pk_mul_f32 v[18:19], v[18:19], v[34:35]
    v_pk_mul_f32 v[20:21], v[20:21], v[36:37]
    v_pk_mul_f32 v[22:23], v[22:23], v[38:39]
    v_rcp_f32 v24, v24
    v_rcp_f32 v25, v25
    v_rcp_f32 v26, v26
    v_rcp_f32 v27, v27
    v_rcp_f32 v28, v28
    v_rcp_f32 v29, v29
    v_rcp_f32 v30, v30
    v_rcp_f32 v31, v31
    v_pk_fma_f32 v[16:17], v[16:17], v[24:25], v[88:89]
    v_pk_fma_f32 v[18:19], v[18:19], v[26:27], v[90:91]
    v_pk_fma_f32 v[20:21], v[20:21], v[28:29], v[92:93]
    v_pk_fma_f32 v[22:23], v[22:23], v[30:31], v[94:95]
    v_cvt_pk_bf16_f32 v24, v16, v17
    v_cvt_pk_bf16_f32 v25, v18, v19
    v_cvt_pk_bf16_f32 v26, v20, v21
    v_cvt_pk_bf16_f32 v27, v22, v23
    global_store_dwordx4 v118, v[24:27], s[26:27]
    s_or_b32 s71, s2, s67
    s_cmp_lg_u32 s71, 0
    s_cselect_b32 s71, 16777216, 0
    buffer_store_dword v2, v9, s[44:47], s71 offen sc1
Lend:
    s_endpgm
Lretry0:
    s_mov_b32 s74, 0
Lspin0:
    s_sleep 1
    ds_read_b128 v[208:211], v11 offset:16
    s_waitcnt lgkmcnt(0)
    v_min_u32 v208, v208, v209
    v_min3_u32 v208, v208, v210, v211
    v_cmp_gt_u32 vcc, 1, v208
    s_nop 4
    s_cbranch_vccz Ldone0
    s_add_u32 s74, s74, 1
    s_cmp_lt_u32 s74, 67108864
    s_cbranch_scc1 Lspin0
    s_branch Ldone0
Lretry1:
    s_mov_b32 s74, 0
Lspin1:
    s_sleep 1
    ds_read_b128 v[208:211], v11 offset:16
    s_waitcnt lgkmcnt(0)
    v_min_u32 v208, v208, v209
    v_min3_u32 v208, v208, v210, v211
    v_cmp_gt_u32 vcc, 6, v208
    s_nop 4
    s_cbranch_vccz Ldone1
    s_add_u32 s74, s74, 1
    s_cmp_lt_u32 s74, 67108864
    s_cbranch_scc1 Lspin1
    s_branch Ldone1
Lretry2:
    s_mov_b32 s74, 0
Lspin2:
    s_sleep 1
    ds_read_b128 v[208:211], v11 offset:16
    s_waitcnt lgkmcnt(0)
    v_min_u32 v208, v208, v209
    v_min3_u32 v208, v208, v210, v211
    v_cmp_gt_u32 vcc, 7, v208
    s_nop 4
    s_cbranch_vccz Ldone2
    s_add_u32 s74, s74, 1
    s_cmp_lt_u32 s74, 67108864
    s_cbranch_scc1 Lspin2
    s_branch Ldone2
Lretry3:
    s_mov_b32 s74, 0
Lspin3:
    s_sleep 1
    ds_read_b128 v[208:211], v11 offset:16
    s_waitcnt lgkmcnt(0)
    v_min_u32 v208, v208, v209
    v_min3_u32 v208, v208, v210, v211
    v_cmp_gt_u32 vcc, 8, v208
    s_nop 4
    s_cbranch_vccz Ldone3
    s_add_u32 s74, s74, 1
    s_cmp_lt_u32 s74, 67108864
    s_cbranch_scc1 Lspin3
    s_branch Ldone3
Lretry4:
    s_mov_b32 s74, 0
Lspin4:
    s_sleep 4
    global_load_dwordx2 v[176:177], v140, s[30:31] offset:0 sc1
    global_load_dwordx2 v[178:179], v140, s[30:31] offset:128 sc1
    global_load_dwordx2 v[180:181], v140, s[30:31] offset:256 sc1
    global_load_dwordx2 v[182:183], v140, s[30:31] offset:384 sc1
    global_load_dwordx4 v[184:187], v143, s[30:31] sc1
    global_load_dwordx4 v[188:191], v143, s[30:31] offset:16 sc1
    s_waitcnt vmcnt(0)
    v_min_u32 v192, v177, v179
    v_max_u32 v193, v177, v179
    v_min3_u32 v192, v192, v181, v183
    v_max3_u32 v193, v193, v181, v183
    v_min3_u32 v192, v192, v185, v187
    v_max3_u32 v193, v193, v185, v187
    v_min3_u32 v192, v192, v189, v191
    v_max3_u32 v193, v193, v189, v191
    v_xor_b32 v192, s3, v192
    v_xor_b32 v193, s3, v193
    v_or_b32 v192, v192, v193
    v_cmp_ne_u32 vcc, 0, v192
    s_nop 4
    s_cbranch_vccz Ldone4
    s_add_u32 s74, s74, 1
    s_cmp_lt_u32 s74, 1048576
    s_cbranch_scc1 Lspin4
    s_branch Ldone4
Lretry5:
    s_mov_b32 s74, 0
Lspin5:
    s_sleep 2
    s_load_dword s50, s[30:31], s48 glc
    s_waitcnt lgkmcnt(0)
    s_cmp_ge_u32 s50, 14
    s_cbranch_scc1 Ldone5
    s_add_u32 s74, s74, 1
    s_cmp_lt_u32 s74, 0x100000
    s_cbranch_scc1 Lspin5
    s_branch Ldone5
Lretry6:
    s_mov_b32 s74, 0
Lspin6:
    s_sleep 2
    s_load_dword s50, s[30:31], s49 glc
    s_waitcnt lgkmcnt(0)
    s_cmp_ge_u32 s50, 14
    s_cbranch_scc1 Ldone6
    s_add_u32 s74, s74, 1
    s_cmp_lt_u32 s74, 0x100000
    s_cbranch_scc1 Lspin6
    s_branch Ldone6
Lretry7:
    s_mov_b32 s74, 0
Lspin7:
    s_sleep 1
    ds_read_b128 v[136:139], v11 offset:0
    s_waitcnt lgkmcnt(0)
    v_min_u32 v136, v136, v137
    v_min3_u32 v136, v136, v138, v139
    v_cmp_gt_u32 vcc, 10, v136
    s_nop 4
    s_cbranch_vccz Ldone7
    s_add_u32 s74, s74, 1
    s_cmp_lt_u32 s74, 67108864
    s_cbranch_scc1 Lspin7
    s_branch Ldone7
Lretry8:
    s_mov_b32 s74, 0
Lspin8:
    s_sleep 2
    s_load_dword s50, s[30:31], s48 glc
    s_waitcnt lgkmcnt(0)
    s_cmp_ge_u32 s50, 16
    s_cbranch_scc1 Ldone8
    s_add_u32 s74, s74, 1
    s_cmp_lt_u32 s74, 0x100000
    s_cbranch_scc1 Lspin8
    s_branch Ldone8
Lretry9:
    s_mov_b32 s74, 0
Lspin9:
    s_sleep 1
    ds_read_b128 v[132:135], v11 offset:16
    s_waitcnt lgkmcnt(0)
    v_min_u32 v132, v132, v133
    v_min3_u32 v132, v132, v134, v135
    v_cmp_gt_u32 vcc, 13, v132
    s_nop 4
    s_cbranch_vccz Ldone9
    s_add_u32 s74, s74, 1
    s_cmp_lt_u32 s74, 67108864
    s_cbranch_scc1 Lspin9
    s_branch Ldone9
Lretry11:
    s_mov_b32 s74, 0
Lspin11:
    s_sleep 1
    ds_read_b128 v[48:51], v11 offset:0
    s_waitcnt lgkmcnt(0)
    v_min_u32 v48, v48, v49
    v_min3_u32 v48, v48, v50, v51
    v_cmp_gt_u32 vcc, 1, v48
    s_nop 4
    s_cbranch_vccz Ldone11
    s_add_u32 s74, s74, 1
    s_cmp_lt_u32 s74, 67108864
    s_cbranch_scc1 Lspin11
    s_branch Ldone11
Lretry14:
    s_mov_b32 s74, 0
Lspin14:
    s_sleep 4
    global_load_dword v60, v61, s[30:31] sc1
    s_waitcnt vmcnt(0)
    v_cmp_ne_u32 vcc, s3, v60
    s_nop 4
    s_cbranch_vccz Ldone14
    s_add_u32 s74, s74, 1
    s_cmp_lt_u32 s74, 1048576
    s_cbranch_scc1 Lspin14
    s_branch Ldone14
Lretry16:
    s_mov_b32 s74, 0
Lspin16:
    s_sleep 1
    ds_read_b128 v[48:51], v11 offset:0
    s_waitcnt lgkmcnt(0)
    v_min_u32 v48, v48, v49
    v_min3_u32 v48, v48, v50, v51
    v_cmp_gt_u32 vcc, 1, v48
    s_nop 4
    s_cbranch_vccz Ldone16
    s_add_u32 s74, s74, 1
    s_cmp_lt_u32 s74, 67108864
    s_cbranch_scc1 Lspin16
    s_branch Ldone16
Lretry19:
    s_mov_b32 s74, 0
Lspin19:
    s_sleep 4
    global_load_dword v60, v61, s[30:31] sc1
    s_waitcnt vmcnt(0)
    v_cmp_ne_u32 vcc, s3, v60
    s_nop 4
    s_cbranch_vccz Ldone19
    s_add_u32 s74, s74, 1
    s_cmp_lt_u32 s74, 1048576
    s_cbranch_scc1 Lspin19
    s_branch Ldone19
Lretry20:
    s_mov_b32 s74, 0
Lspin20:
    s_sleep 1
    ds_read_b128 v[64:67], v11 offset:0
    s_waitcnt lgkmcnt(0)
    v_min_u32 v64, v64, v65
    v_min3_u32 v64, v64, v66, v67
    v_cmp_gt_u32 vcc, 6, v64
    s_nop 4
    s_cbranch_vccz Ldone20
    s_add_u32 s74, s74, 1
    s_cmp_lt_u32 s74, 67108864
    s_cbranch_scc1 Lspin20
    s_branch Ldone20
Lretry21:
    s_mov_b32 s74, 0
Lspin21:
    s_sleep 1
    ds_read_b128 v[64:67], v11 offset:0
    s_waitcnt lgkmcnt(0)
    v_min_u32 v64, v64, v65
    v_min3_u32 v64, v64, v66, v67
    v_cmp_gt_u32 vcc, 7, v64
    s_nop 4
    s_cbranch_vccz Ldone21
    s_add_u32 s74, s74, 1
    s_cmp_lt_u32 s74, 67108864
    s_cbranch_scc1 Lspin21
    s_branch Ldone21
Lretry22:
    s_mov_b32 s74, 0
Lspin22:
    s_sleep 1
    ds_read_b128 v[64:67], v11 offset:16
    s_waitcnt lgkmcnt(0)
    v_min_u32 v64, v64, v65
    v_min3_u32 v64, v64, v66, v67
    v_cmp_gt_u32 vcc, 10, v64
    s_nop 4
    s_cbranch_vccz Ldone22
    s_add_u32 s74, s74, 1
    s_cmp_lt_u32 s74, 67108864
    s_cbranch_scc1 Lspin22
    s_branch Ldone22
Lretry23:
    s_mov_b32 s74, 0
Lspin23:
    s_sleep 1
    ds_read_b128 v[132:135], v11 offset:0
    s_waitcnt lgkmcnt(0)
    v_min_u32 v132, v132, v133
    v_min3_u32 v132, v132, v134, v135
    v_cmp_gt_u32 vcc, 9, v132
    s_nop 4
    s_cbranch_vccz Ldone23
    s_add_u32 s74, s74, 1
    s_cmp_lt_u32 s74, 67108864
    s_cbranch_scc1 Lspin23
    s_branch Ldone23
Lretry24:
    s_mov_b32 s74, 0
Lspin24:
    ds_read_b32 v72, v12
    s_waitcnt lgkmcnt(0)
    v_cmp_gt_u32 vcc, 12, v72
    s_nop 4
    s_cbranch_vccz Ldone24
    s_add_u32 s74, s74, 1
    s_cmp_lt_u32 s74, 67108864
    s_cbranch_scc1 Lspin24
    s_branch Ldone24
Lretry25:
    s_mov_b32 s74, 0
Lspin25:
    s_sleep 1
    ds_read_b128 v[132:135], v11 offset:0
    s_waitcnt lgkmcnt(0)
    v_min_u32 v132, v132, v133
    v_min3_u32 v132, v132, v134, v135
    v_cmp_gt_u32 vcc, 9, v132
    s_nop 4
    s_cbranch_vccz Ldone25
    s_add_u32 s74, s74, 1
    s_cmp_lt_u32 s74, 67108864
    s_cbranch_scc1 Lspin25
    s_branch Ldone25
Lretry26:
    s_mov_b32 s74, 0
Lspin26:
    ds_read_b32 v72, v12
    s_waitcnt lgkmcnt(0)
    v_cmp_gt_u32 vcc, 12, v72
    s_nop 4
    s_cbranch_vccz Ldone26
    s_add_u32 s74, s74, 1
    s_cmp_lt_u32 s74, 67108864
    s_cbranch_scc1 Lspin26
    s_branch Ldone26
Lretry27:
    s_mov_b32 s74, 0
Lspin27:
    s_sleep 2
    s_load_dword s50, s[30:31], s48 glc
    s_waitcnt lgkmcnt(0)
    s_cmp_ge_u32 s50, 14
    s_cbranch_scc1 Ldone27
    s_add_u32 s74, s74, 1
    s_cmp_lt_u32 s74, 0x100000
    s_cbranch_scc1 Lspin27
    s_branch Ldone27
Lretry28:
    s_mov_b32 s74, 0
Lspin28:
    s_sleep 2
    s_load_dword s50, s[30:31], s49 glc
    s_waitcnt lgkmcnt(0)
    s_cmp_ge_u32 s50, 14
    s_cbranch_scc1 Ldone28
    s_add_u32 s74, s74, 1
    s_cmp_lt_u32 s74, 0x100000
    s_cbranch_scc1 Lspin28
    s_branch Ldone28
Lretry29:
    s_mov_b32 s74, 0
Lspin29:
    s_sleep 1
    ds_read_b128 v[136:139], v11 offset:16
    s_waitcnt lgkmcnt(0)
    v_min_u32 v136, v136, v137
    v_min3_u32 v136, v136, v138, v139
    v_cmp_gt_u32 vcc, 13, v136
    s_nop 4
    s_cbranch_vccz Ldone29
    s_add_u32 s74, s74, 1
    s_cmp_lt_u32 s74, 67108864
    s_cbranch_scc1 Lspin29
    s_branch Ldone29
.p2align 6
.type Ltab,@object
Ltab:
    .short 2880, 2880, 2880, 2880, 2860, 2860, 2860, 2860
    .short 2860, 2860, 2860, 2856, 2856, 2856, 2856, 2856
    .short 2856, 2856, 2856, 2856, 2852, 2852, 2852, 2852
    .short 2852, 2852, 2852, 2848, 2848, 2848, 2848, 2848
    .short 2848, 2848, 2848, 2848, 2844, 2844, 2844, 2844
    .short 2844, 2844, 2844, 2840, 2840, 2840, 2840, 2840
    .short 2840, 2840, 2840, 2840, 2836, 2836, 2836, 2836
    .short 2836, 2836, 2836, 2832, 2832, 2832, 2832, 2832
    .short 2832, 2832, 2832, 2832, 2828, 2828, 2828, 2828
    .short 2828, 2828, 2828, 2824, 2824, 2824, 2824, 2824
    .short 2824, 2824, 2824, 2824, 2820, 2820, 2820, 2820
    .short 2820, 2820, 2820, 2816, 2816, 2816, 2816, 2816
    .short 2816, 2816, 2816, 2816, 2812, 2812, 2812, 2812
    .short 2812, 2812, 2812, 2808, 2808, 2808, 2808, 2808
    .short 2808, 2808, 2808, 2808, 2804, 2804, 2804, 2804
    .short 2804, 2804, 2804, 2800, 2800, 2800, 2800, 2800
    .short 2800, 2800, 2800, 2800, 2796, 2796, 2796, 2796
    .short 2796, 2796, 2796, 2792, 2792, 2792, 2792, 2792
    .short 2792, 2792, 2792, 2792, 2788, 2788, 2788, 2788
    .short 2788, 2788, 2788, 2784, 2784, 2784, 2784, 2784
    .short 2784, 2784, 2784, 2784, 2780, 2780, 2780, 2780
    .short 2780, 2780, 2780, 2776, 2776, 2776, 2776, 2776
    .short 2776, 2776, 2776, 2776, 2772, 2772, 2772, 2772
    .short 2772, 2772, 2772, 2768, 2768, 2768, 2768, 2768
    .short 2768, 2768, 2768, 2768, 2764, 2764, 2764, 2764
    .short 2764, 2764, 2764, 2760, 2760, 2760, 2760, 2760
    .short 2760, 2760, 2760, 2760, 2756, 2756, 2756, 2756
    .short 2756, 2756, 2756, 2752, 2752, 2752, 2752, 2752
    .short 2752, 2752, 2752, 2752, 2748, 2748, 2748, 2748
    .short 2748, 2748, 2748, 2744, 2744, 2744, 2744, 2744
    .short 2744, 2744, 2744, 2744, 2740, 2740, 2740, 2740
    .short 2740, 2740, 2740, 2736, 2736, 2736, 2736, 2736
    .short 2736, 2736, 2736, 2736, 2716, 2716, 2716, 2716
    .short 2716, 2716, 2716, 2712, 2712, 2712, 2712, 2712
    .short 2712, 2712, 2712, 2712, 2708, 2708, 2708, 2708
    .short 2708, 2708, 2708, 2704, 2704, 2704, 2704, 2704
    .short 2704, 2704, 2704, 2704, 2700, 2700, 2700, 2700
    .short 2700, 2700, 2700, 2696, 2696, 2696, 2696, 2696
    .short 2696, 2696, 2696, 2696, 2692, 2692, 2692, 2692
    .short 2692, 2692, 2692, 2688, 2688, 2688, 2688, 2688
    .short 2688, 2688, 2688, 2688, 2684, 2684, 2684, 2684
    .short 2684, 2684, 2684, 2680, 2680, 2680, 2680, 2680
    .short 2680, 2680, 2680, 2680, 2676, 2676, 2676, 2676
    .short 2676, 2676, 2676, 2672, 2672, 2672, 2672, 2672
    .short 2672, 2672, 2672, 2672, 2668, 2668, 2668, 2668
    .short 2668, 2668, 2668, 2664, 2664, 2664, 2664, 2664
    .short 2664, 2664, 2664, 2664, 2660, 2660, 2660, 2660
    .short 2660, 2660, 2660, 2656, 2656, 2656, 2656, 2656
    .short 2656, 2656, 2656, 2656, 2652, 2652, 2652, 2652
    .short 2652, 2652, 2652, 2648, 2648, 2648, 2648, 2648
    .short 2648, 2648, 2648, 2648, 2644, 2644, 2644, 2644
    .short 2644, 2644, 2644, 2640, 2640, 2640, 2640, 2640
    .short 2640, 2640, 2640, 2640, 2636, 2636, 2636, 2636
    .short 2636, 2636, 2636, 2632, 2632, 2632, 2632, 2632
    .short 2632, 2632, 2632, 2632, 2628, 2628, 2628, 2628
    .short 2628, 2628, 2628, 2624, 2624, 2624, 2624, 2624
    .short 2624, 2624, 2624, 2624, 2620, 2620, 2620, 2620
    .short 2620, 2620, 2620, 2616, 2616, 2616, 2616, 2616
    .short 2616, 2616, 2616, 2616, 2612, 2612, 2612, 2612
    .short 2612, 2612, 2612, 2608, 2608, 2608, 2608, 2608
    .short 2608, 2608, 2608, 2608, 2604, 2604, 2604, 2604
    .short 2604, 2604, 2604, 2600, 2600, 2600, 2600, 2600
    .short 2600, 2600, 2600, 2600, 2596, 2596, 2596, 2596
    .short 2596, 2596, 2596, 2592, 2592, 2592, 2592, 2592
    .short 2592, 2592, 2592, 2592, 2572, 2572, 2572, 2572
    .short 2572, 2572, 2572, 2568, 2568, 2568, 2568, 2568
    .short 2568, 2568, 2568, 2568, 2564, 2564, 2564, 2564
    .short 2564, 2564, 2564, 2560, 2560, 2560, 2560, 2560
    .short 2560, 2560, 2560, 2560, 2556, 2556, 2556, 2556
    .short 2556, 2556, 2556, 2552, 2552, 2552, 2552, 2552
    .short 2552, 2552, 2552, 2552, 2548, 2548, 2548, 2548
    .short 2548, 2548, 2548, 2544, 2544, 2544, 2544, 2544
    .short 2544, 2544, 2544, 2544, 2540, 2540, 2540, 2540
    .short 2540, 2540, 2540, 2536, 2536, 2536, 2536, 2536
    .short 2536, 2536, 2536, 2536, 2532, 2532, 2532, 2532
    .short 2532, 2532, 2532, 2528, 2528, 2528, 2528, 2528
    .short 2528, 2528, 2528, 2528, 2524, 2524, 2524, 2524
    .short 2524, 2524, 2524, 2520, 2520, 2520, 2520, 2520
    .short 2520, 2520, 2520, 2520, 2516, 2516, 2516, 2516
    .short 2516, 2516, 2516, 2512, 2512, 2512, 2512, 2512
    .short 2512, 2512, 2512, 2512, 2508, 2508, 2508, 2508
    .short 2508, 2508, 2508, 2504, 2504, 2504, 2504, 2504
    .short 2504, 2504, 2504, 2504, 2500, 2500, 2500, 2500
    .short 2500, 2500, 2500, 2496, 2496, 2496, 2496, 2496
    .short 2496, 2496, 2496, 2496, 2492, 2492, 2492, 2492
    .short 2492, 2492, 2492, 2488, 2488, 2488, 2488, 2488
    .short 2488, 2488, 2488, 2488, 2484, 2484, 2484, 2484
    .short 2484, 2484, 2484, 2480, 2480, 2480, 2480, 2480
    .short 2480, 2480, 2480, 2480, 2476, 2476, 2476, 2476
    .short 2476, 2476, 2476, 2472, 2472, 2472, 2472, 2472
    .short 2472, 2472, 2472, 2472, 2468, 2468, 2468, 2468
    .short 2468, 2468, 2468, 2464, 2464, 2464, 2464, 2464
    .short 2464, 2464, 2464, 2464, 2460, 2460, 2460, 2460
    .short 2460, 2460, 2460, 2456, 2456, 2456, 2456, 2456
    .short 2456, 2456, 2456, 2456, 2452, 2452, 2452, 2452
    .short 2452, 2452, 2452, 2448, 2448, 2448, 2448, 2448
    .short 2448, 2448, 2448, 2448, 2428, 2428, 2428, 2428
    .short 2428, 2428, 2428, 2424, 2424, 2424, 2424, 2424
    .short 2424, 2424, 2424, 2424, 2420, 2420, 2420, 2420
    .short 2420, 2420, 2420, 2416, 2416, 2416, 2416, 2416
    .short 2416, 2416, 2416, 2416, 2412, 2412, 2412, 2412
    .short 2412, 2412, 2412, 2408, 2408, 2408, 2408, 2408
    .short 2408, 2408, 2408, 2408, 2404, 2404, 2404, 2404
    .short 2404, 2404, 2404, 2400, 2400, 2400, 2400, 2400
    .short 2400, 2400, 2400, 2400, 2396, 2396, 2396, 2396
    .short 2396, 2396, 2396, 2392, 2392, 2392, 2392, 2392
    .short 2392, 2392, 2392, 2392, 2388, 2388, 2388, 2388
    .short 2388, 2388, 2388, 2384, 2384, 2384, 2384, 2384
    .short 2384, 2384, 2384, 2384, 2380, 2380, 2380, 2380
    .short 2380, 2380, 2380, 2376, 2376, 2376, 2376, 2376
    .short 2376, 2376, 2376, 2376, 2372, 2372, 2372, 2372
    .short 2372, 2372, 2372, 2368, 2368, 2368, 2368, 2368
    .short 2368, 2368, 2368, 2368, 2364, 2364, 2364, 2364
    .short 2364, 2364, 2364, 2360, 2360, 2360, 2360, 2360
    .short 2360, 2360, 2360, 2360, 2356, 2356, 2356, 2356
    .short 2356, 2356, 2356, 2352, 2352, 2352, 2352, 2352
    .short 2352, 2352, 2352, 2352, 2348, 2348, 2348, 2348
    .short 2348, 2348, 2348, 2344, 2344, 2344, 2344, 2344
    .short 2344, 2344, 2344, 2344, 2340, 2340, 2340, 2340
    .short 2340, 2340, 2340, 2336, 2336, 2336, 2336, 2336
    .short 2336, 2336, 2336, 2336, 2332, 2332, 2332, 2332
    .short 2332, 2332, 2332, 2328, 2328, 2328, 2328, 2328
    .short 2328, 2328, 2328, 2328, 2324, 2324, 2324, 2324
    .short 2324, 2324, 2324, 2320, 2320, 2320, 2320, 2320
    .short 2320, 2320, 2320, 2320, 2316, 2316, 2316, 2316
    .short 2316, 2316, 2316, 2312, 2312, 2312, 2312, 2312
    .short 2312, 2312, 2312, 2312, 2308, 2308, 2308, 2308
    .short 2308, 2308, 2308, 2304, 2304, 2304, 2304, 2304
    .short 2304, 2304, 2284, 2284, 2284, 2140, 2140, 2140
    .short 2140, 2140, 2280, 2280, 2280, 2136, 2136, 2136
    .short 2136, 2136, 2276, 2276, 2276, 2132, 2132, 2132
    .short 2132, 2132, 2272, 2272, 2272, 2128, 2128, 2128
    .short 2128, 2128, 2268, 2268, 2268, 2124, 2124, 2124
    .short 2124, 2124, 2264, 2264, 2264, 2120, 2120, 2120
    .short 2120, 2120, 2260, 2260, 2260, 2116, 2116, 2116
    .short 2116, 2116, 2256, 2256, 2256, 2112, 2112, 2112
    .short 2112, 2112, 2252, 2252, 2252, 2108, 2108, 2108
    .short 2108, 2108, 2248, 2248, 2248, 2104, 2104, 2104
    .short 2104, 2104, 2244, 2244, 2244, 2100, 2100, 2100
    .short 2100, 2100, 2240, 2240, 2240, 2096, 2096, 2096
    .short 2096, 2096, 2236, 2236, 2236, 2092, 2092, 2092
    .short 2092, 2092, 2232, 2232, 2232, 2088, 2088, 2088
    .short 2088, 2088, 2228, 2228, 2228, 2084, 2084, 2084
    .short 2084, 2084, 2224, 2224, 2224, 2080, 2080, 2080
    .short 2080, 2080, 2220, 2220, 2220, 2076, 2076, 2076
    .short 2076, 2076, 2216, 2216, 2216, 2072, 2072, 2072
    .short 2072, 2072, 2212, 2212, 2212, 2068, 2068, 2068
    .short 2068, 2068, 2208, 2208, 2208, 2064, 2064, 2064
    .short 2064, 2064, 2204, 2204, 2204, 2060, 2060, 2060
    .short 2060, 2060, 2200, 2200, 2200, 2056, 2056, 2056
    .short 2056, 2056, 2196, 2196, 2196, 2052, 2052, 2052
    .short 2052, 2052, 2192, 2192, 2192, 2048, 2048, 2048
    .short 2048, 2048, 2188, 2188, 2188, 2044, 2044, 2044
    .short 2044, 2044, 2184, 2184, 2184, 2040, 2040, 2040
    .short 2040, 2040, 2180, 2180, 2180, 2036, 2036, 2036
    .short 2036, 2036, 2176, 2176, 2176, 2032, 2032, 2032
    .short 2032, 2032, 2172, 2172, 2172, 2028, 2028, 2028
    .short 2028, 2028, 2168, 2168, 2168, 2024, 2024, 2024
    .short 2024, 2024, 2164, 2164, 2164, 2020, 2020, 2020
    .short 2020, 2020, 2160, 2160, 2160, 2016, 2016, 2016
    .short 2016, 2016, 1996, 1996, 1996, 1852, 1852, 1852
    .short 1852, 1852, 1992, 1992, 1992, 1848, 1848, 1848
    .short 1848, 1848, 1988, 1988, 1988, 1844, 1844, 1844
    .short 1844, 1844, 1984, 1984, 1984, 1840, 1840, 1840
    .short 1840, 1840, 1980, 1980, 1980, 1836, 1836, 1836
    .short 1836, 1836, 1976, 1976, 1976, 1832, 1832, 1832
    .short 1832, 1832, 1972, 1972, 1972, 1828, 1828, 1828
    .short 1828, 1828, 1968, 1968, 1968, 1824, 1824, 1824
    .short 1824, 1824, 1964, 1964, 1964, 1820, 1820, 1820
    .short 1820, 1820, 1960, 1960, 1960, 1816, 1816, 1816
    .short 1816, 1816, 1956, 1956, 1956, 1812, 1812, 1812
    .short 1812, 1812, 1952, 1952, 1952, 1808, 1808, 1808
    .short 1808, 1808, 1948, 1948, 1948, 1804, 1804, 1804
    .short 1804, 1804, 1944, 1944, 1944, 1800, 1800, 1800
    .short 1800, 1800, 1940, 1940, 1940, 1796, 1796, 1796
    .short 1796, 1796, 1936, 1936, 1936, 1792, 1792, 1792
    .short 1792, 1792, 1932, 1932, 1932, 1788, 1788, 1788
    .short 1788, 1788, 1928, 1928, 1928, 1784, 1784, 1784
    .short 1784, 1784, 1924, 1924, 1924, 1780, 1780, 1780
    .short 1780, 1780, 1920, 1920, 1920, 1776, 1776, 1776
    .short 1776, 1776, 1916, 1916, 1916, 1772, 1772, 1772
    .short 1772, 1772, 1912, 1912, 1912, 1768, 1768, 1768
    .short 1768, 1768, 1908, 1908, 1908, 1764, 1764, 1764
    .short 1764, 1764, 1904, 1904, 1904, 1760, 1760, 1760
    .short 1760, 1760, 1900, 1900, 1900, 1756, 1756, 1756
    .short 1756, 1756, 1896, 1896, 1896, 1752, 1752, 1752
    .short 1752, 1752, 1892, 1892, 1892, 1748, 1748, 1748
    .short 1748, 1748, 1888, 1888, 1888, 1744, 1744, 1744
    .short 1744, 1744, 1884, 1884, 1884, 1740, 1740, 1740
    .short 1740, 1740, 1880, 1880, 1880, 1736, 1736, 1736
    .short 1736, 1736, 1876, 1876, 1876, 1732, 1732, 1732
    .short 1732, 1732, 1872, 1872, 1872, 1728, 1728, 1728
    .short 1728, 1708, 1564, 1564, 1564, 1420, 1276, 1276
    .short 1276, 1704, 1560, 1560, 1560, 1416, 1272, 1272
    .short 1272, 1700, 1556, 1556, 1556, 1412, 1268, 1268
    .short 1268, 1696, 1552, 1552, 1552, 1408, 1264, 1264
    .short 1264, 1692, 1548, 1548, 1548, 1404, 1260, 1260
    .short 1260, 1688, 1544, 1544, 1544, 1400, 1256, 1256
    .short 1256, 1684, 1540, 1540, 1540, 1396, 1252, 1252
    .short 1252, 1680, 1536, 1536, 1536, 1392, 1248, 1248
    .short 1248, 1676, 1532, 1532, 1532, 1388, 1244, 1244
    .short 1244, 1672, 1528, 1528, 1528, 1384, 1240, 1240
    .short 1240, 1668, 1524, 1524, 1524, 1380, 1236, 1236
    .short 1236, 1664, 1520, 1520, 1520, 1376, 1232, 1232
    .short 1232, 1660, 1516, 1516, 1516, 1372, 1228, 1228
    .short 1228, 1656, 1512, 1512, 1512, 1368, 1224, 1224
    .short 1224, 1652, 1508, 1508, 1508, 1364, 1220, 1220
    .short 1220, 1648, 1504, 1504, 1504, 1360, 1216, 1216
    .short 1216, 1644, 1500, 1500, 1500, 1356, 1212, 1212
    .short 1212, 1640, 1496, 1496, 1496, 1352, 1208, 1208
    .short 1208, 1636, 1492, 1492, 1492, 1348, 1204, 1204
    .short 1204, 1632, 1488, 1488, 1488, 1344, 1200, 1200
    .short 1200, 1628, 1484, 1484, 1484, 1340, 1196, 1196
    .short 1196, 1624, 1480, 1480, 1480, 1336, 1192, 1192
    .short 1192, 1620, 1476, 1476, 1476, 1332, 1188, 1188
    .short 1188, 1616, 1472, 1472, 1472, 1328, 1184, 1184
    .short 1184, 1612, 1468, 1468, 1468, 1324, 1180, 1180
    .short 1180, 1608, 1464, 1464, 1464, 1320, 1176, 1176
    .short 1176, 1604, 1460, 1460, 1460, 1316, 1172, 1172
    .short 1172, 1600, 1456, 1456, 1456, 1312, 1168, 1168
    .short 1168, 1596, 1452, 1452, 1452, 1308, 1164, 1164
    .short 1164, 1592, 1448, 1448, 1448, 1304, 1160, 1160
    .short 1160, 1588, 1444, 1444, 1444, 1300, 1156, 1156
    .short 1156, 1584, 1440, 1440, 1440, 1296, 1152, 1152
    .short 1132, 988, 844, 700, 556, 412, 268, 124
    .short 1128, 984, 840, 696, 552, 408, 264, 120
    .short 1124, 980, 836, 692, 548, 404, 260, 116
    .short 1120, 976, 832, 688, 544, 400, 256, 112
    .short 1116, 972, 828, 684, 540, 396, 252, 108
    .short 1112, 968, 824, 680, 536, 392, 248, 104
    .short 1108, 964, 820, 676, 532, 388, 244, 100
    .short 1104, 960, 816, 672, 528, 384, 240, 96
    .short 1100, 956, 812, 668, 524, 380, 236, 92
    .short 1096, 952, 808, 664, 520, 376, 232, 88
    .short 1092, 948, 804, 660, 516, 372, 228, 84
    .short 1088, 944, 800, 656, 512, 368, 224, 80
    .short 1084, 940, 796, 652, 508, 364, 220, 76
    .short 1080, 936, 792, 648, 504, 360, 216, 72
    .short 1076, 932, 788, 644, 500, 356, 212, 68
    .short 1072, 928, 784, 640, 496, 352, 208, 64
    .short 1068, 924, 780, 636, 492, 348, 204, 60
    .short 1064, 920, 776, 632, 488, 344, 200, 56
    .short 1060, 916, 772, 628, 484, 340, 196, 52
    .short 1056, 912, 768, 624, 480, 336, 192, 48
    .short 1052, 908, 764, 620, 476, 332, 188, 44
    .short 1048, 904, 760, 616, 472, 328, 184, 40
    .short 1044, 900, 756, 612, 468, 324, 180, 36
    .short 1040, 896, 752, 608, 464, 320, 176, 32
    .short 1036, 892, 748, 604, 460, 316, 172, 28
    .short 1032, 888, 744, 600, 456, 312, 168, 24
    .short 1028, 884, 740, 596, 452, 308, 164, 20
    .short 1024, 880, 736, 592, 448, 304, 160, 16
    .short 1020, 876, 732, 588, 444, 300, 156, 12
    .short 1016, 872, 728, 584, 440, 296, 152, 8
    .short 1012, 868, 724, 580, 436, 292, 148, 4
    .short 1008, 864, 720, 576, 432, 288, 144, 0
    .short 3168, 3168, 3168, 3168, 3168, 3168, 3168, 3168
Ltabend:
.size Ltab, 4112
.section .rodata,"a"
.p2align 6
.amdhsa_kernel recurrent_scan__ssm_conv_s4d__dense_activation_mish__prompt_kernel
  .amdhsa_next_free_vgpr 256
  .amdhsa_next_free_sgpr 98
  .amdhsa_accum_offset 256
  .amdhsa_group_segment_fixed_size 0
  .amdhsa_kernarg_size 112
  .amdhsa_user_sgpr_count 2
  .amdhsa_user_sgpr_kernarg_segment_ptr 1
  .amdhsa_system_sgpr_workgroup_id_x 1
.end_amdhsa_kernel
```
